```python
import torch

def _softmax(x, axis=-1):
    return torch.softmax(x, dim=axis)
def _gelu(x):
    return torch.nn.functional.gelu(x, approximate="tanh")
def _silu(x):
    return torch.nn.functional.silu(x)
def _sigmoid(x):
    return torch.sigmoid(x)
def _layernorm(x, axis=-1, eps=1e-5):
    m = x.mean(dim=axis, keepdim=True)
    v = x.var(dim=axis, keepdim=True, unbiased=False)
    return (x - m) / torch.sqrt(v + eps)
def _scatter_add(tgt, idx, src, axis=0):
    return tgt.clone().index_add_(axis, idx, src)
def _segment_sum(src, seg, n):
    out = torch.zeros((n,) + src.shape[1:], dtype=src.dtype)
    return out.index_add_(0, seg, src)
def _pad(x, pw):
    flat = tuple(v for pair in reversed(pw) for v in pair)
    return torch.nn.functional.pad(x, flat)

kernel_name = 'sequential_preLN__softmax_full_mha__dense_activation_gelu__prompt'

def setup_inputs():

    _w = (lambda a: (lambda t: t.to(torch.bfloat16) if t.is_floating_point() else t)(torch.as_tensor(a)))
    def _A_setup():
        B, S, D = 1, 2048, 1024
        return {
            "x": _w((lambda *s: torch.randn(*s, dtype=torch.bfloat16) * 0.05)(B, S, D)),
            "wqkv": _w((lambda *s: torch.randn(*s, dtype=torch.bfloat16) * 0.05)(D, 3 * D)),
            "wo": _w((lambda *s: torch.randn(*s, dtype=torch.bfloat16) * 0.05)(D, D)),
        }
    _A_in = _A_setup()

    def _B_setup():
        B, S, D, F = 1, 2048, 1024, 3584
        return {
            "x": _w((lambda *s: torch.randn(*s, dtype=torch.bfloat16) * 0.05)(B, S, D)),
            "w1": _w((lambda *s: torch.randn(*s, dtype=torch.bfloat16) * 3.2)(D, F) * (D ** -0.5)),
            "b1": _w((lambda *s: torch.randn(*s, dtype=torch.bfloat16) * 3.2)(F) * 0.01),
            "w2": _w((lambda *s: torch.randn(*s, dtype=torch.bfloat16) * 0.4)(F, D) * (F ** -0.5)),
            "b2": _w((lambda *s: torch.randn(*s, dtype=torch.bfloat16) * 0.4)(D) * 0.01),
        }
    _B_in = _B_setup()

    return {
        "A_x": _A_in["x"],
        "A_wqkv": _A_in["wqkv"],
        "A_wo": _A_in["wo"],
        "B_x": _B_in["x"],
        "B_w1": _B_in["w1"],
        "B_b1": _B_in["b1"],
        "B_w2": _B_in["w2"],
        "B_b2": _B_in["b2"],
    }

def reference(A_x, A_wqkv, A_wo, B_x, B_w1, B_b1, B_w2, B_b2):
    def _A_ref(x, wqkv, wo):
        B, S, D = x.shape
        H = 32; Dh = D // H
        qkv = (lambda x, *d: x.permute(*d))((x @ wqkv).reshape(B, S, 3, H, Dh), 2, 0, 3, 1, 4)
        q, k, v = qkv[0], qkv[1], qkv[2]
        scale = Dh ** -0.5
        scores = torch.einsum("bhqd,bhkd->bhqk", q, k) * scale
        p = _softmax(scores, axis=-1)
        o = torch.einsum("bhqk,bhkd->bhqd", p, v)
        return (lambda x, *d: x.permute(*d))(o, 0, 2, 1, 3).reshape(B, S, D) @ wo

    def _B_ref(x, w1, b1, w2, b2):
        h = torch.einsum("bsd,df->bsf", x, w1) + b1
        h = _gelu(h)
        return torch.einsum("bsf,fd->bsd", h, w2) + b2

    x = A_x
    h = x + _A_ref(_layernorm(x, axis=-1), A_wqkv, A_wo)
    h2 = h + _B_ref(_layernorm(h, axis=-1), B_w1, B_b1, B_w2, B_b2)
    return h2
```

```asm
; @launch grid=(256,1,1) block=(512,1,1) lds=163840
.amdgcn_target "amdgcn-amd-amdhsa--gfx950"
.text
.globl sequential_preLN__softmax_full_mha__dense_activation_gelu__prompt_kernel
.p2align 8
.type sequential_preLN__softmax_full_mha__dense_activation_gelu__prompt_kernel,@function
sequential_preLN__softmax_full_mha__dense_activation_gelu__prompt_kernel:
  s_cmp_ge_u32 s2, 256
  s_cbranch_scc0 main_go
  s_endpgm
main_go:
  s_load_dwordx2 s[4:5], s[0:1], 80
  s_load_dwordx2 s[88:89], s[0:1], 0
  s_load_dwordx2 s[90:91], s[0:1], 16
  s_load_dwordx8 s[92:99], s[0:1], 32
  s_load_dwordx2 s[100:101], s[0:1], 64
  s_load_dwordx2 s[6:7], s[0:1], 8
  s_load_dwordx2 s[86:87], s[0:1], 72
  v_lshrrev_b32 v1, 6, v0
  v_and_b32 v0, 63, v0
  s_mov_b32 s42, 0
  v_readfirstlane_b32 s62, v1
  s_waitcnt lgkmcnt(0)
  s_and_b32 s10, s62, 3
  s_lshl_b32 s42, s2, 7
  s_add_u32 s42, s42, 229376
  s_cmp_lt_u32 s62, 4
  s_cbranch_scc1 ln1_ln
  s_movk_i32 s30, 6144
  s_cmp_eq_u32 s62, 7
  s_cbranch_scc0 ln1_na
  s_add_u32 s56, s4, 0x2a00000
  s_addc_u32 s57, s5, 0
  s_mov_b32 s58, 0x40000
  s_mov_b32 s59, 0x20000
  v_lshlrev_b32 v8, 4, v0
  v_mov_b32 v16, 0
  v_mov_b32 v17, 0
  v_mov_b32 v18, 0
  v_mov_b32 v19, 0
  s_lshl_b32 s22, s2, 10
  buffer_store_dwordx4 v[16:19], v8, s[56:59], s22 offen sc1
  s_and_b32 s22, s2, 3
  s_lshl_b32 s22, s22, 6
  v_mov_b32 v8, s22
  v_mov_b32 v9, 1
  s_mov_b64 exec, 1
  s_waitcnt vmcnt(0)
  global_atomic_add v8, v9, s[86:87] sc1
  s_mov_b64 exec, -1
  s_barrier
ln1_na:
  s_lshr_b32 s31, s2, 3
  s_and_b32 s32, s2, 7
  s_cmp_eq_u32 s10, 3
  s_cselect_b32 s24, s90, s6
  s_cselect_b32 s25, s91, s7
  s_cselect_b32 s26, 2, 6
  s_mov_b32 s27, 0x20000
  s_cselect_b32 s30, 0x800, s30
  s_cselect_b32 s38, 0, s10
  s_cselect_b32 s39, 4, 12
  s_cselect_b32 s40, 6291456, 0
  s_cselect_b32 s41, 4, 8
  s_cselect_b32 s43, 8, 4
  s_mul_i32 s41, s41, s30
  s_mul_i32 s43, s43, s30
  s_lshl_b32 s46, s30, 4
  s_lshl_b32 s26, s26, 20
  v_lshrrev_b32 v11, 4, v0
  v_and_b32 v12, 15, v0
  v_lshlrev_b32 v13, 1, v11
  v_xor_b32 v12, v12, v13
  v_mul_lo_u32 v10, v11, s30
  v_lshl_add_u32 v10, v12, 4, v10
  v_xor_b32 v11, 0x80, v10
  s_lshl_b32 s38, s38, 11
  s_mul_i32 s33, s31, s30
  s_lshl_b32 s33, s33, 5
  s_lshl_b32 s34, s32, 8
  s_add_u32 s33, s33, s34
  s_add_u32 s33, s33, s38
  s_lshl_b32 s35, s10, 13
  s_add_u32 s35, s35, 0x20000
  s_add_u32 m0, s35, 0
  s_mov_b32 s34, s33
  buffer_load_dwordx4 v10, s[24:27], s34 offen nt lds
  s_add_u32 m0, s35, 1024
  s_mov_b32 s34, s33
  s_add_u32 s34, s34, s41
  buffer_load_dwordx4 v11, s[24:27], s34 offen nt lds
  s_add_u32 m0, s35, 2048
  s_mov_b32 s34, s33
  s_add_u32 s34, s34, s46
  buffer_load_dwordx4 v10, s[24:27], s34 offen nt lds
  s_add_u32 m0, s35, 3072
  s_mov_b32 s34, s33
  s_add_u32 s34, s34, s46
  s_add_u32 s34, s34, s41
  buffer_load_dwordx4 v11, s[24:27], s34 offen nt lds
  s_add_u32 m0, s35, 4096
  s_mov_b32 s34, s33
  s_add_u32 s34, s34, s43
  buffer_load_dwordx4 v10, s[24:27], s34 offen nt lds
  s_add_u32 m0, s35, 5120
  s_mov_b32 s34, s33
  s_add_u32 s34, s34, s41
  s_add_u32 s34, s34, s43
  buffer_load_dwordx4 v11, s[24:27], s34 offen nt lds
  s_add_u32 m0, s35, 6144
  s_mov_b32 s34, s33
  s_add_u32 s34, s34, s46
  s_add_u32 s34, s34, s43
  buffer_load_dwordx4 v10, s[24:27], s34 offen nt lds
  s_add_u32 m0, s35, 7168
  s_mov_b32 s34, s33
  s_add_u32 s34, s34, s46
  s_add_u32 s34, s34, s41
  s_add_u32 s34, s34, s43
  buffer_load_dwordx4 v11, s[24:27], s34 offen nt lds
  s_add_u32 s48, s4, 0x3000000
  s_addc_u32 s49, s5, 0
  s_mov_b32 s50, 0x800000
  s_mov_b32 s51, 0x20000
  v_lshrrev_b32 v14, 2, v0
  v_and_b32 v15, 7, v14
  v_lshlrev_b32 v14, 8, v14
  v_lshl_add_u32 v14, v15, 5, v14
  v_and_b32 v15, 3, v0
  v_lshl_add_u32 v14, v15, 3, v14
  v_add_u32 v14, s35, v14
  s_lshl_b32 s33, s32, 6
  s_add_u32 s33, s33, s31
  s_mul_i32 s33, s33, s39
  s_lshl_b32 s33, s33, 10
  s_add_u32 s33, s33, s40
  s_add_u32 s52, s33, s38
  s_lshl_b32 s34, s39, 9
  s_add_u32 s53, s52, s34
  s_lshl_b32 s34, s39, 15
  s_add_u32 s54, s52, s34
  s_add_u32 s55, s53, s34
  v_lshlrev_b32 v7, 4, v0
  s_cmp_eq_u32 s62, 7
  s_cbranch_scc1 ln1_nc
  s_barrier
ln1_nc:
  s_barrier
  s_waitcnt vmcnt(0)
  v_xor_b32 v15, 0, v14
  ds_read_b64_tr_b16 v[64:65], v15
  ds_read_b64_tr_b16 v[66:67], v15 offset:4096
  v_xor_b32 v15, 32, v14
  ds_read_b64_tr_b16 v[68:69], v15
  ds_read_b64_tr_b16 v[70:71], v15 offset:4096
  v_xor_b32 v15, 64, v14
  ds_read_b64_tr_b16 v[72:73], v15
  ds_read_b64_tr_b16 v[74:75], v15 offset:4096
  v_xor_b32 v15, 96, v14
  ds_read_b64_tr_b16 v[76:77], v15
  ds_read_b64_tr_b16 v[78:79], v15 offset:4096
  v_xor_b32 v15, 128, v14
  ds_read_b64_tr_b16 v[80:81], v15
  ds_read_b64_tr_b16 v[82:83], v15 offset:4096
  v_xor_b32 v15, 160, v14
  ds_read_b64_tr_b16 v[84:85], v15
  ds_read_b64_tr_b16 v[86:87], v15 offset:4096
  v_xor_b32 v15, 192, v14
  ds_read_b64_tr_b16 v[88:89], v15
  ds_read_b64_tr_b16 v[90:91], v15 offset:4096
  v_xor_b32 v15, 224, v14
  ds_read_b64_tr_b16 v[92:93], v15
  ds_read_b64_tr_b16 v[94:95], v15 offset:4096
  s_waitcnt lgkmcnt(12)
  buffer_store_dwordx4 v[64:67], v7, s[48:51], s52 offen offset:0 sc1
  buffer_store_dwordx4 v[68:71], v7, s[48:51], s52 offen offset:1024 sc1
  s_waitcnt lgkmcnt(8)
  buffer_store_dwordx4 v[72:75], v7, s[48:51], s53 offen offset:0 sc1
  buffer_store_dwordx4 v[76:79], v7, s[48:51], s53 offen offset:1024 sc1
  s_waitcnt lgkmcnt(4)
  buffer_store_dwordx4 v[80:83], v7, s[48:51], s54 offen offset:0 sc1
  buffer_store_dwordx4 v[84:87], v7, s[48:51], s54 offen offset:1024 sc1
  s_waitcnt lgkmcnt(0)
  buffer_store_dwordx4 v[88:91], v7, s[48:51], s55 offen offset:0 sc1
  buffer_store_dwordx4 v[92:95], v7, s[48:51], s55 offen offset:1024 sc1
  s_branch ln1_end
ln1_ln:
  v_and_b32 v2, 7, v0
  v_lshrrev_b32 v3, 3, v0
  v_lshlrev_b32 v4, 11, v2
  v_lshl_add_u32 v4, v3, 4, v4
  s_lshl_b32 s20, s2, 14
  s_lshl_b32 s21, s10, 9
  s_add_u32 s21, s21, s20
  s_mov_b32 s12, s88
  s_mov_b32 s13, s89
  s_mov_b32 s14, 0x400000
  s_mov_b32 s15, 0x20000
  buffer_load_dwordx4 v[16:19], v4, s[12:15], s21 offen offset:0
  buffer_load_dwordx4 v[20:23], v4, s[12:15], s21 offen offset:128
  buffer_load_dwordx4 v[24:27], v4, s[12:15], s21 offen offset:256
  buffer_load_dwordx4 v[28:31], v4, s[12:15], s21 offen offset:384
  s_getpc_b64 s[28:29]
pc1:
  s_add_u32 s28, s28, main_go-pc1
  s_addc_u32 s29, s29, (main_go-pc1)>>32
  s_lshr_b32 s30, s2, 3
  s_lshl_b32 s30, s30, 11
  v_lshl_add_u32 v8, v0, 4, s30
  s_mov_b32 s30, main_end-main_go
  s_mov_b32 s31, 0x20000
  buffer_load_dwordx4 v[252:255], v8, s[28:31], 0 offen
  buffer_load_dwordx4 v[252:255], v8, s[28:31], 0 offen offset:1024
  s_mov_b32 s16, s4
  s_mov_b32 s17, s5
  s_mov_b32 s18, 0x400000
  s_mov_b32 s19, 0x20000
  s_lshr_b32 s22, s2, 1
  s_lshl_b32 s22, s22, 15
  s_and_b32 s23, s2, 1
  s_lshl_b32 s23, s23, 7
  s_add_u32 s22, s22, s23
  s_lshl_b32 s23, s10, 13
  s_add_u32 s22, s22, s23
  s_add_u32 s23, s22, 4096
  v_lshlrev_b32 v5, 4, v2
  s_lshl_b32 s36, s10, 2
  v_add_u32 v6, s36, v5
  v_lshl_add_u32 v7, v3, 8, v5
  v_mov_b32 v8, 0
  v_mov_b32 v9, 0
  s_waitcnt vmcnt(5)
  v_lshlrev_b32 v32, 16, v16
  v_and_b32 v33, 0xffff0000, v16
  v_pk_add_f32 v[8:9], v[8:9], v[32:33]
  v_lshlrev_b32 v34, 16, v17
  v_and_b32 v35, 0xffff0000, v17
  v_pk_add_f32 v[8:9], v[8:9], v[34:35]
  v_lshlrev_b32 v36, 16, v18
  v_and_b32 v37, 0xffff0000, v18
  v_pk_add_f32 v[8:9], v[8:9], v[36:37]
  v_lshlrev_b32 v38, 16, v19
  v_and_b32 v39, 0xffff0000, v19
  v_pk_add_f32 v[8:9], v[8:9], v[38:39]
  s_waitcnt vmcnt(4)
  v_lshlrev_b32 v40, 16, v20
  v_and_b32 v41, 0xffff0000, v20
  v_pk_add_f32 v[8:9], v[8:9], v[40:41]
  v_lshlrev_b32 v42, 16, v21
  v_and_b32 v43, 0xffff0000, v21
  v_pk_add_f32 v[8:9], v[8:9], v[42:43]
  v_lshlrev_b32 v44, 16, v22
  v_and_b32 v45, 0xffff0000, v22
  v_pk_add_f32 v[8:9], v[8:9], v[44:45]
  v_lshlrev_b32 v46, 16, v23
  v_and_b32 v47, 0xffff0000, v23
  v_pk_add_f32 v[8:9], v[8:9], v[46:47]
  s_waitcnt vmcnt(3)
  v_lshlrev_b32 v48, 16, v24
  v_and_b32 v49, 0xffff0000, v24
  v_pk_add_f32 v[8:9], v[8:9], v[48:49]
  v_lshlrev_b32 v50, 16, v25
  v_and_b32 v51, 0xffff0000, v25
  v_pk_add_f32 v[8:9], v[8:9], v[50:51]
  v_lshlrev_b32 v52, 16, v26
  v_and_b32 v53, 0xffff0000, v26
  v_pk_add_f32 v[8:9], v[8:9], v[52:53]
  v_lshlrev_b32 v54, 16, v27
  v_and_b32 v55, 0xffff0000, v27
  v_pk_add_f32 v[8:9], v[8:9], v[54:55]
  s_waitcnt vmcnt(2)
  v_lshlrev_b32 v56, 16, v28
  v_and_b32 v57, 0xffff0000, v28
  v_pk_add_f32 v[8:9], v[8:9], v[56:57]
  v_lshlrev_b32 v58, 16, v29
  v_and_b32 v59, 0xffff0000, v29
  v_pk_add_f32 v[8:9], v[8:9], v[58:59]
  v_lshlrev_b32 v60, 16, v30
  v_and_b32 v61, 0xffff0000, v30
  v_pk_add_f32 v[8:9], v[8:9], v[60:61]
  v_lshlrev_b32 v62, 16, v31
  v_and_b32 v63, 0xffff0000, v31
  v_pk_add_f32 v[8:9], v[8:9], v[62:63]
  v_add_f32 v8, v8, v9
  s_nop 1
  v_add_f32_dpp v8, v8, v8 row_ror:8 row_mask:0xf bank_mask:0xf
  v_mov_b32 v9, v8
  s_nop 1
  v_permlane16_swap_b32 v8, v9
  s_nop 1
  v_add_f32 v8, v8, v9
  v_mov_b32 v9, v8
  s_nop 1
  v_permlane32_swap_b32 v8, v9
  s_nop 1
  v_add_f32 v8, v8, v9
  ds_write_b32 v6, v8 offset:0
  s_waitcnt lgkmcnt(0)
  s_barrier
  ds_read_b128 v[64:67], v5 offset:0
  s_waitcnt lgkmcnt(0)
  v_add_f32 v12, v64, v65
  v_add_f32 v13, v66, v67
  v_add_f32 v12, v12, v13
  v_mul_f32 v10, 0xba800000, v12
  v_mov_b32 v8, 0
  v_mov_b32 v9, 0
  v_pk_add_f32 v[32:33], v[32:33], v[10:11] op_sel_hi:[1,0]
  v_pk_add_f32 v[34:35], v[34:35], v[10:11] op_sel_hi:[1,0]
  v_pk_add_f32 v[36:37], v[36:37], v[10:11] op_sel_hi:[1,0]
  v_pk_add_f32 v[38:39], v[38:39], v[10:11] op_sel_hi:[1,0]
  v_pk_add_f32 v[40:41], v[40:41], v[10:11] op_sel_hi:[1,0]
  v_pk_add_f32 v[42:43], v[42:43], v[10:11] op_sel_hi:[1,0]
  v_pk_add_f32 v[44:45], v[44:45], v[10:11] op_sel_hi:[1,0]
  v_pk_add_f32 v[46:47], v[46:47], v[10:11] op_sel_hi:[1,0]
  v_pk_add_f32 v[48:49], v[48:49], v[10:11] op_sel_hi:[1,0]
  v_pk_add_f32 v[50:51], v[50:51], v[10:11] op_sel_hi:[1,0]
  v_pk_add_f32 v[52:53], v[52:53], v[10:11] op_sel_hi:[1,0]
  v_pk_add_f32 v[54:55], v[54:55], v[10:11] op_sel_hi:[1,0]
  v_pk_add_f32 v[56:57], v[56:57], v[10:11] op_sel_hi:[1,0]
  v_pk_add_f32 v[58:59], v[58:59], v[10:11] op_sel_hi:[1,0]
  v_pk_add_f32 v[60:61], v[60:61], v[10:11] op_sel_hi:[1,0]
  v_pk_add_f32 v[62:63], v[62:63], v[10:11] op_sel_hi:[1,0]
  v_pk_fma_f32 v[8:9], v[32:33], v[32:33], v[8:9]
  v_pk_fma_f32 v[8:9], v[34:35], v[34:35], v[8:9]
  v_pk_fma_f32 v[8:9], v[36:37], v[36:37], v[8:9]
  v_pk_fma_f32 v[8:9], v[38:39], v[38:39], v[8:9]
  v_pk_fma_f32 v[8:9], v[40:41], v[40:41], v[8:9]
  v_pk_fma_f32 v[8:9], v[42:43], v[42:43], v[8:9]
  v_pk_fma_f32 v[8:9], v[44:45], v[44:45], v[8:9]
  v_pk_fma_f32 v[8:9], v[46:47], v[46:47], v[8:9]
  v_pk_fma_f32 v[8:9], v[48:49], v[48:49], v[8:9]
  v_pk_fma_f32 v[8:9], v[50:51], v[50:51], v[8:9]
  v_pk_fma_f32 v[8:9], v[52:53], v[52:53], v[8:9]
  v_pk_fma_f32 v[8:9], v[54:55], v[54:55], v[8:9]
  v_pk_fma_f32 v[8:9], v[56:57], v[56:57], v[8:9]
  v_pk_fma_f32 v[8:9], v[58:59], v[58:59], v[8:9]
  v_pk_fma_f32 v[8:9], v[60:61], v[60:61], v[8:9]
  v_pk_fma_f32 v[8:9], v[62:63], v[62:63], v[8:9]
  v_add_f32 v8, v8, v9
  s_nop 1
  v_add_f32_dpp v8, v8, v8 row_ror:8 row_mask:0xf bank_mask:0xf
  v_mov_b32 v9, v8
  s_nop 1
  v_permlane16_swap_b32 v8, v9
  s_nop 1
  v_add_f32 v8, v8, v9
  v_mov_b32 v9, v8
  s_nop 1
  v_permlane32_swap_b32 v8, v9
  s_nop 1
  v_add_f32 v8, v8, v9
  ds_write_b32 v6, v8 offset:256
  s_waitcnt lgkmcnt(0)
  s_barrier
  ds_read_b128 v[64:67], v5 offset:256
  s_waitcnt lgkmcnt(0)
  v_add_f32 v12, v64, v65
  v_add_f32 v13, v66, v67
  v_add_f32 v12, v12, v13
  v_mov_b32 v13, 0x3727c5ac
  v_fmac_f32 v13, 0x3a800000, v12
  v_rsq_f32 v10, v13
  s_nop 0
  v_pk_mul_f32 v[32:33], v[32:33], v[10:11] op_sel_hi:[1,0]
  v_pk_mul_f32 v[34:35], v[34:35], v[10:11] op_sel_hi:[1,0]
  v_pk_mul_f32 v[36:37], v[36:37], v[10:11] op_sel_hi:[1,0]
  v_pk_mul_f32 v[38:39], v[38:39], v[10:11] op_sel_hi:[1,0]
  v_cvt_pk_bf16_f32 v16, v32, v33
  v_cvt_pk_bf16_f32 v17, v34, v35
  v_cvt_pk_bf16_f32 v18, v36, v37
  v_cvt_pk_bf16_f32 v19, v38, v39
  buffer_store_dwordx4 v[16:19], v7, s[16:19], s22 offen offset:0 sc1
  v_pk_mul_f32 v[40:41], v[40:41], v[10:11] op_sel_hi:[1,0]
  v_pk_mul_f32 v[42:43], v[42:43], v[10:11] op_sel_hi:[1,0]
  v_pk_mul_f32 v[44:45], v[44:45], v[10:11] op_sel_hi:[1,0]
  v_pk_mul_f32 v[46:47], v[46:47], v[10:11] op_sel_hi:[1,0]
  v_cvt_pk_bf16_f32 v20, v40, v41
  v_cvt_pk_bf16_f32 v21, v42, v43
  v_cvt_pk_bf16_f32 v22, v44, v45
  v_cvt_pk_bf16_f32 v23, v46, v47
  buffer_store_dwordx4 v[20:23], v7, s[16:19], s22 offen offset:2048 sc1
  v_pk_mul_f32 v[48:49], v[48:49], v[10:11] op_sel_hi:[1,0]
  v_pk_mul_f32 v[50:51], v[50:51], v[10:11] op_sel_hi:[1,0]
  v_pk_mul_f32 v[52:53], v[52:53], v[10:11] op_sel_hi:[1,0]
  v_pk_mul_f32 v[54:55], v[54:55], v[10:11] op_sel_hi:[1,0]
  v_cvt_pk_bf16_f32 v24, v48, v49
  v_cvt_pk_bf16_f32 v25, v50, v51
  v_cvt_pk_bf16_f32 v26, v52, v53
  v_cvt_pk_bf16_f32 v27, v54, v55
  buffer_store_dwordx4 v[24:27], v7, s[16:19], s23 offen offset:0 sc1
  v_pk_mul_f32 v[56:57], v[56:57], v[10:11] op_sel_hi:[1,0]
  v_pk_mul_f32 v[58:59], v[58:59], v[10:11] op_sel_hi:[1,0]
  v_pk_mul_f32 v[60:61], v[60:61], v[10:11] op_sel_hi:[1,0]
  v_pk_mul_f32 v[62:63], v[62:63], v[10:11] op_sel_hi:[1,0]
  v_cvt_pk_bf16_f32 v28, v56, v57
  v_cvt_pk_bf16_f32 v29, v58, v59
  v_cvt_pk_bf16_f32 v30, v60, v61
  v_cvt_pk_bf16_f32 v31, v62, v63
  buffer_store_dwordx4 v[28:31], v7, s[16:19], s23 offen offset:2048 sc1
  s_cmp_eq_u32 s62, 1
  s_cbranch_scc0 ln1_end
  v_and_b32 v8, 3, v0
  v_lshlrev_b32 v8, 6, v8
  s_mov_b32 s63, 0x40000
ln1_cz:
  global_load_dword v9, v8, s[86:87] sc1
  s_sub_u32 s63, s63, 1
  s_waitcnt vmcnt(0)
  v_cmp_gt_u32 vcc, 64, v9
  s_nop 3
  s_cbranch_scc1 ln1_end
  s_cbranch_vccz ln1_end
  s_sleep 8
  s_branch ln1_cz
ln1_end:
qkv:
  s_mov_b32 s8, s62
  s_and_b32 s24, s2, 7
  s_lshl_b32 s24, s24, 2
  s_lshr_b32 s10, s2, 6
  s_add_u32 s10, s10, s24
  s_bfe_u32 s9, s2, 0x30003
  s_cmp_lt_u32 s8, 4
  s_cbranch_scc1 qkv_comp
  s_sub_u32 s8, s8, 4
  s_mov_b32 s25, s8
  s_lshl_b32 s24, s9, 4
  s_lshl_b32 s25, s25, 2
  s_add_u32 s24, s24, s25
  s_mul_i32 s24, s24, 32768
  v_lshl_add_u32 v2, v0, 4, s24
  v_add_u32 v3, 32768, v2
  s_mul_i32 s21, s10, 196608
  s_mov_b32 s20, 0
  s_mul_i32 s24, s8, 3072
  v_lshl_add_u32 v4, v0, 4, s24
  v_add_u32 v5, 4096, v4
  v_add_u32 v6, 65536, v2
  v_add_u32 v7, 98304, v2
  s_lshr_b32 s21, s10, 1
  s_mul_i32 s21, s21, 393216
  s_and_b32 s24, s10, 1
  s_mul_i32 s24, s24, 6144
  s_add_u32 s21, s21, s24
  s_lshr_b32 s24, s8, 1
  s_mul_i32 s24, s24, 12288
  s_and_b32 s25, s8, 1
  s_mul_i32 s25, s25, 3072
  s_add_u32 s24, s24, s25
  v_lshl_add_u32 v4, v0, 4, s24
  s_mul_i32 s44, s8, 8192
  s_mul_i32 s45, s8, 3072
  s_add_u32 s45, s45, 32768
  s_mov_b32 s12, s4
  s_mov_b32 s13, s5
  s_mov_b32 s14, 0x400000
  s_mov_b32 s15, 0x20000
  s_add_u32 s16, s4, 0x3000000
  s_addc_u32 s17, s5, 0
  s_mov_b32 s18, 0x600000
  s_mov_b32 s19, 0x20000
  s_waitcnt vmcnt(0)
  s_barrier
  s_barrier
  s_add_u32 m0, s45, 0
  s_nop 0
  buffer_load_dwordx4 v4, s[16:19], s21 offen offset:0 sc1 lds
  buffer_load_dwordx4 v4, s[16:19], s21 offen offset:1024 sc1 lds
  buffer_load_dwordx4 v4, s[16:19], s21 offen offset:2048 sc1 lds
  s_add_u32 s21, s21, 24576
  s_add_u32 m0, s44, 0
  s_nop 0
  buffer_load_dwordx4 v2, s[12:15], s20 offen offset:0 sc1 lds
  buffer_load_dwordx4 v2, s[12:15], s20 offen offset:1024 sc1 lds
  s_add_u32 m0, s44, 2048
  s_nop 0
  buffer_load_dwordx4 v3, s[12:15], s20 offen offset:0 sc1 lds
  buffer_load_dwordx4 v3, s[12:15], s20 offen offset:1024 sc1 lds
  s_add_u32 m0, s44, 4096
  s_nop 0
  buffer_load_dwordx4 v6, s[12:15], s20 offen offset:0 sc1 lds
  buffer_load_dwordx4 v6, s[12:15], s20 offen offset:1024 sc1 lds
  s_add_u32 m0, s44, 6144
  s_nop 0
  buffer_load_dwordx4 v7, s[12:15], s20 offen offset:0 sc1 lds
  buffer_load_dwordx4 v7, s[12:15], s20 offen offset:1024 sc1 lds
  s_add_u32 s20, s20, 2048
  s_add_u32 m0, s45, 45056
  s_nop 0
  buffer_load_dwordx4 v4, s[16:19], s21 offen offset:0 sc1 lds
  buffer_load_dwordx4 v4, s[16:19], s21 offen offset:1024 sc1 lds
  buffer_load_dwordx4 v4, s[16:19], s21 offen offset:2048 sc1 lds
  s_add_u32 s21, s21, 24576
  s_add_u32 m0, s44, 45056
  s_nop 0
  buffer_load_dwordx4 v2, s[12:15], s20 offen offset:0 sc1 lds
  buffer_load_dwordx4 v2, s[12:15], s20 offen offset:1024 sc1 lds
  s_add_u32 m0, s44, 47104
  s_nop 0
  buffer_load_dwordx4 v3, s[12:15], s20 offen offset:0 sc1 lds
  buffer_load_dwordx4 v3, s[12:15], s20 offen offset:1024 sc1 lds
  s_add_u32 m0, s44, 49152
  s_nop 0
  buffer_load_dwordx4 v6, s[12:15], s20 offen offset:0 sc1 lds
  buffer_load_dwordx4 v6, s[12:15], s20 offen offset:1024 sc1 lds
  s_add_u32 m0, s44, 51200
  s_nop 0
  buffer_load_dwordx4 v7, s[12:15], s20 offen offset:0 sc1 lds
  buffer_load_dwordx4 v7, s[12:15], s20 offen offset:1024 sc1 lds
  s_add_u32 s20, s20, 2048
  s_waitcnt vmcnt(11)
  s_barrier
  s_mov_b32 s22, 90112
  s_mov_b32 s23, 2
qkv_ld:
  s_add_u32 s46, s22, s44
  s_add_u32 s47, s22, s45
  s_add_u32 m0, s47, 0
  s_nop 0
  buffer_load_dwordx4 v4, s[16:19], s21 offen offset:0 sc1 lds
  buffer_load_dwordx4 v4, s[16:19], s21 offen offset:1024 sc1 lds
  buffer_load_dwordx4 v4, s[16:19], s21 offen offset:2048 sc1 lds
  s_add_u32 s21, s21, 24576
  s_add_u32 m0, s46, 0
  s_nop 0
  buffer_load_dwordx4 v2, s[12:15], s20 offen offset:0 sc1 lds
  buffer_load_dwordx4 v2, s[12:15], s20 offen offset:1024 sc1 lds
  s_add_u32 m0, s46, 2048
  s_nop 0
  buffer_load_dwordx4 v3, s[12:15], s20 offen offset:0 sc1 lds
  buffer_load_dwordx4 v3, s[12:15], s20 offen offset:1024 sc1 lds
  s_add_u32 m0, s46, 4096
  s_nop 0
  buffer_load_dwordx4 v6, s[12:15], s20 offen offset:0 sc1 lds
  buffer_load_dwordx4 v6, s[12:15], s20 offen offset:1024 sc1 lds
  s_add_u32 m0, s46, 6144
  s_nop 0
  buffer_load_dwordx4 v7, s[12:15], s20 offen offset:0 sc1 lds
  buffer_load_dwordx4 v7, s[12:15], s20 offen offset:1024 sc1 lds
  s_add_u32 s20, s20, 2048
  s_add_u32 s22, s22, 45056
  s_cmp_eq_u32 s22, 135168
  s_cselect_b32 s22, 0, s22
  s_add_u32 s23, s23, 1
  s_cmp_lt_u32 s23, 3
  s_cbranch_scc1 qkv_ld
  s_waitcnt vmcnt(11)
  s_barrier
  s_cmp_lt_u32 s23, 16
  s_cbranch_scc1 qkv_ld
  s_waitcnt vmcnt(0)
  s_barrier
  s_waitcnt vmcnt(0)
  s_barrier
  s_lshl_b32 s24, s10, 10
  s_lshl_b32 s25, s9, 7
  s_add_u32 s24, s24, s25
  s_add_u32 s42, s24, 0
  s_getpc_b64 s[28:29]
pc2:
  s_add_u32 s28, s28, main_go-pc2
  s_addc_u32 s29, s29, (main_go-pc2)>>32
  s_lshr_b32 s30, s2, 3
  s_lshl_b32 s30, s30, 11
  v_lshl_add_u32 v8, v0, 4, s30
  s_mov_b32 s30, main_end-main_go
  s_mov_b32 s31, 0x20000
  buffer_load_dwordx4 v[252:255], v8, s[28:31], 0 offen sc1
  buffer_load_dwordx4 v[252:255], v8, s[28:31], 0 offen offset:1024 sc1
  s_branch attn
qkv_comp:
  s_mov_b32 s11, s8
  s_mov_b32 s3, 0
  v_and_b32 v1, 15, v0
  v_lshrrev_b32 v2, 4, v0
  s_mul_i32 s24, s11, 8192
  v_lshl_add_u32 v3, v0, 4, s24
  s_mul_i32 s24, s3, 6144
  s_add_u32 s24, s24, 32768
  v_lshl_add_u32 v4, v0, 4, s24
  v_mov_b32 v6, v3
  v_mov_b32 v7, v4
  s_lshl_b32 s27, s9, 4
  s_mul_i32 s24, s11, 4
  s_add_u32 s27, s27, s24
  v_mov_b32 v16, 0
  v_mov_b32 v17, 0
  v_mov_b32 v18, 0
  v_mov_b32 v19, 0
  v_mov_b32 v20, 0
  v_mov_b32 v21, 0
  v_mov_b32 v22, 0
  v_mov_b32 v23, 0
  v_mov_b32 v24, 0
  v_mov_b32 v25, 0
  v_mov_b32 v26, 0
  v_mov_b32 v27, 0
  v_mov_b32 v28, 0
  v_mov_b32 v29, 0
  v_mov_b32 v30, 0
  v_mov_b32 v31, 0
  v_mov_b32 v32, 0
  v_mov_b32 v33, 0
  v_mov_b32 v34, 0
  v_mov_b32 v35, 0
  v_mov_b32 v36, 0
  v_mov_b32 v37, 0
  v_mov_b32 v38, 0
  v_mov_b32 v39, 0
  v_mov_b32 v40, 0
  v_mov_b32 v41, 0
  v_mov_b32 v42, 0
  v_mov_b32 v43, 0
  v_mov_b32 v44, 0
  v_mov_b32 v45, 0
  v_mov_b32 v46, 0
  v_mov_b32 v47, 0
  v_mov_b32 v48, 0
  v_mov_b32 v49, 0
  v_mov_b32 v50, 0
  v_mov_b32 v51, 0
  v_mov_b32 v52, 0
  v_mov_b32 v53, 0
  v_mov_b32 v54, 0
  v_mov_b32 v55, 0
  v_mov_b32 v56, 0
  v_mov_b32 v57, 0
  v_mov_b32 v58, 0
  v_mov_b32 v59, 0
  v_mov_b32 v60, 0
  v_mov_b32 v61, 0
  v_mov_b32 v62, 0
  v_mov_b32 v63, 0
  v_mov_b32 v64, 0
  v_mov_b32 v65, 0
  v_mov_b32 v66, 0
  v_mov_b32 v67, 0
  v_mov_b32 v68, 0
  v_mov_b32 v69, 0
  v_mov_b32 v70, 0
  v_mov_b32 v71, 0
  v_mov_b32 v72, 0
  v_mov_b32 v73, 0
  v_mov_b32 v74, 0
  v_mov_b32 v75, 0
  v_mov_b32 v76, 0
  v_mov_b32 v77, 0
  v_mov_b32 v78, 0
  v_mov_b32 v79, 0
  v_mov_b32 v80, 0
  v_mov_b32 v81, 0
  v_mov_b32 v82, 0
  v_mov_b32 v83, 0
  v_mov_b32 v84, 0
  v_mov_b32 v85, 0
  v_mov_b32 v86, 0
  v_mov_b32 v87, 0
  v_mov_b32 v88, 0
  v_mov_b32 v89, 0
  v_mov_b32 v90, 0
  v_mov_b32 v91, 0
  v_mov_b32 v92, 0
  v_mov_b32 v93, 0
  v_mov_b32 v94, 0
  v_mov_b32 v95, 0
  v_mov_b32 v96, 0
  v_mov_b32 v97, 0
  v_mov_b32 v98, 0
  v_mov_b32 v99, 0
  v_mov_b32 v100, 0
  v_mov_b32 v101, 0
  v_mov_b32 v102, 0
  v_mov_b32 v103, 0
  v_mov_b32 v104, 0
  v_mov_b32 v105, 0
  v_mov_b32 v106, 0
  v_mov_b32 v107, 0
  v_mov_b32 v108, 0
  v_mov_b32 v109, 0
  v_mov_b32 v110, 0
  v_mov_b32 v111, 0
  s_lshl_b32 s60, s9, 12
  s_add_u32 s60, s60, 229376
  s_lshr_b32 s61, s10, 2
  v_and_b32 v112, 31, v0
  v_lshl_add_u32 v112, v112, 7, s60
  v_and_b32 v113, 31, v0
  v_lshl_add_u32 v113, v113, 3, s61
  v_lshlrev_b32 v113, 7, v113
  v_cmp_gt_u32 vcc, 32, v0
  v_add_u32 v113, 229376, v113
  s_mov_b32 s60, 0
  v_cndmask_b32 v112, v113, v112, vcc
  s_waitcnt vmcnt(0)
  s_add_u32 s36, s4, 0x2a00000
  s_addc_u32 s37, s5, 0
  s_mov_b32 s38, 0x40000
  s_mov_b32 s39, 0x20000
  s_barrier
  s_cmp_eq_u32 s62, 0
  s_cbranch_scc0 ho3a
  v_mov_b32 v114, 0
  v_mov_b32 v115, 1
  s_mov_b64 exec, 1
  buffer_store_dword v115, v114, s[36:39], s42 offen sc1
  s_mov_b64 exec, -1
ho3a:
  s_cmp_eq_u32 s62, 1
  s_cbranch_scc0 ho3
  s_mov_b32 s63, 0x40000
poll4:
  buffer_load_dword v116, v112, s[36:39], s60 offen sc1
  s_sub_u32 s63, s63, 1
  s_waitcnt vmcnt(0)
  v_cmp_eq_u32 vcc, 0, v116
  s_nop 3
  s_cbranch_scc1 poll4x
  s_cbranch_vccz poll4x
  s_sleep 2
  s_branch poll4
poll4x:
ho3:
  s_barrier
  s_mov_b32 s22, 0
  s_mov_b32 s23, 16
  s_barrier
  ds_read_b128 v[128:131], v7 offset:0
  ds_read_b128 v[112:115], v6 offset:0
  ds_read_b128 v[116:119], v6 offset:2048
  ds_read_b128 v[120:123], v6 offset:4096
  ds_read_b128 v[124:127], v6 offset:6144
  ds_read_b128 v[132:135], v7 offset:1024
  ds_read_b128 v[136:139], v7 offset:2048
  ds_read_b128 v[140:143], v7 offset:3072
  ds_read_b128 v[144:147], v7 offset:4096
  ds_read_b128 v[148:151], v7 offset:5120
  .p2align 5
qkv_loop:
  s_waitcnt lgkmcnt(0)
  v_mfma_f32_16x16x32_bf16 v[16:19], v[128:131], v[112:115], v[16:19]
  ds_read_b128 v[168:171], v7 offset:6144
  v_mfma_f32_16x16x32_bf16 v[40:43], v[128:131], v[116:119], v[40:43]
  ds_read_b128 v[152:155], v6 offset:1024
  v_mfma_f32_16x16x32_bf16 v[64:67], v[128:131], v[120:123], v[64:67]
  ds_read_b128 v[156:159], v6 offset:3072
  v_mfma_f32_16x16x32_bf16 v[88:91], v[128:131], v[124:127], v[88:91]
  ds_read_b128 v[160:163], v6 offset:5120
  v_mfma_f32_16x16x32_bf16 v[92:95], v[132:135], v[124:127], v[92:95]
  ds_read_b128 v[164:167], v6 offset:7168
  v_mfma_f32_16x16x32_bf16 v[68:71], v[132:135], v[120:123], v[68:71]
  ds_read_b128 v[172:175], v7 offset:7168
  v_mfma_f32_16x16x32_bf16 v[44:47], v[132:135], v[116:119], v[44:47]
  ds_read_b128 v[176:179], v7 offset:8192
  v_mfma_f32_16x16x32_bf16 v[20:23], v[132:135], v[112:115], v[20:23]
  ds_read_b128 v[180:183], v7 offset:9216
  v_mfma_f32_16x16x32_bf16 v[24:27], v[136:139], v[112:115], v[24:27]
  ds_read_b128 v[184:187], v7 offset:10240
  v_mfma_f32_16x16x32_bf16 v[48:51], v[136:139], v[116:119], v[48:51]
  ds_read_b128 v[188:191], v7 offset:11264
  v_mfma_f32_16x16x32_bf16 v[72:75], v[136:139], v[120:123], v[72:75]
  s_add_u32 s22, s22, 45056
  v_mfma_f32_16x16x32_bf16 v[96:99], v[136:139], v[124:127], v[96:99]
  s_cmp_eq_u32 s22, 135168
  v_mfma_f32_16x16x32_bf16 v[100:103], v[140:143], v[124:127], v[100:103]
  s_cselect_b32 s22, 0, s22
  v_mfma_f32_16x16x32_bf16 v[76:79], v[140:143], v[120:123], v[76:79]
  v_add_u32 v6, s22, v3
  v_mfma_f32_16x16x32_bf16 v[52:55], v[140:143], v[116:119], v[52:55]
  v_add_u32 v7, s22, v4
  v_mfma_f32_16x16x32_bf16 v[28:31], v[140:143], v[112:115], v[28:31]
  v_mfma_f32_16x16x32_bf16 v[32:35], v[112:115], v[144:147], v[32:35]
  v_mfma_f32_16x16x32_bf16 v[56:59], v[116:119], v[144:147], v[56:59]
  v_mfma_f32_16x16x32_bf16 v[80:83], v[120:123], v[144:147], v[80:83]
  v_mfma_f32_16x16x32_bf16 v[104:107], v[124:127], v[144:147], v[104:107]
  v_mfma_f32_16x16x32_bf16 v[108:111], v[124:127], v[148:151], v[108:111]
  v_mfma_f32_16x16x32_bf16 v[84:87], v[120:123], v[148:151], v[84:87]
  v_mfma_f32_16x16x32_bf16 v[60:63], v[116:119], v[148:151], v[60:63]
  v_mfma_f32_16x16x32_bf16 v[36:39], v[112:115], v[148:151], v[36:39]
  s_waitcnt lgkmcnt(0)
  s_barrier
  v_mfma_f32_16x16x32_bf16 v[16:19], v[168:171], v[152:155], v[16:19]
  ds_read_b128 v[128:131], v7 offset:0
  v_mfma_f32_16x16x32_bf16 v[40:43], v[168:171], v[156:159], v[40:43]
  ds_read_b128 v[112:115], v6 offset:0
  v_mfma_f32_16x16x32_bf16 v[64:67], v[168:171], v[160:163], v[64:67]
  ds_read_b128 v[116:119], v6 offset:2048
  v_mfma_f32_16x16x32_bf16 v[88:91], v[168:171], v[164:167], v[88:91]
  ds_read_b128 v[120:123], v6 offset:4096
  v_mfma_f32_16x16x32_bf16 v[92:95], v[172:175], v[164:167], v[92:95]
  ds_read_b128 v[124:127], v6 offset:6144
  v_mfma_f32_16x16x32_bf16 v[68:71], v[172:175], v[160:163], v[68:71]
  ds_read_b128 v[132:135], v7 offset:1024
  v_mfma_f32_16x16x32_bf16 v[44:47], v[172:175], v[156:159], v[44:47]
  ds_read_b128 v[136:139], v7 offset:2048
  v_mfma_f32_16x16x32_bf16 v[20:23], v[172:175], v[152:155], v[20:23]
  ds_read_b128 v[140:143], v7 offset:3072
  v_mfma_f32_16x16x32_bf16 v[24:27], v[176:179], v[152:155], v[24:27]
  ds_read_b128 v[144:147], v7 offset:4096
  v_mfma_f32_16x16x32_bf16 v[48:51], v[176:179], v[156:159], v[48:51]
  ds_read_b128 v[148:151], v7 offset:5120
  v_mfma_f32_16x16x32_bf16 v[72:75], v[176:179], v[160:163], v[72:75]
  v_mfma_f32_16x16x32_bf16 v[96:99], v[176:179], v[164:167], v[96:99]
  v_mfma_f32_16x16x32_bf16 v[100:103], v[180:183], v[164:167], v[100:103]
  v_mfma_f32_16x16x32_bf16 v[76:79], v[180:183], v[160:163], v[76:79]
  v_mfma_f32_16x16x32_bf16 v[52:55], v[180:183], v[156:159], v[52:55]
  v_mfma_f32_16x16x32_bf16 v[28:31], v[180:183], v[152:155], v[28:31]
  v_mfma_f32_16x16x32_bf16 v[32:35], v[152:155], v[184:187], v[32:35]
  v_mfma_f32_16x16x32_bf16 v[56:59], v[156:159], v[184:187], v[56:59]
  v_mfma_f32_16x16x32_bf16 v[80:83], v[160:163], v[184:187], v[80:83]
  v_mfma_f32_16x16x32_bf16 v[104:107], v[164:167], v[184:187], v[104:107]
  v_mfma_f32_16x16x32_bf16 v[108:111], v[164:167], v[188:191], v[108:111]
  v_mfma_f32_16x16x32_bf16 v[84:87], v[160:163], v[188:191], v[84:87]
  v_mfma_f32_16x16x32_bf16 v[60:63], v[156:159], v[188:191], v[60:63]
  v_mfma_f32_16x16x32_bf16 v[36:39], v[152:155], v[188:191], v[36:39]
  s_waitcnt lgkmcnt(0)
  v_mfma_f32_16x16x32_bf16 v[16:19], v[128:131], v[112:115], v[16:19]
  ds_read_b128 v[168:171], v7 offset:6144
  v_mfma_f32_16x16x32_bf16 v[40:43], v[128:131], v[116:119], v[40:43]
  ds_read_b128 v[152:155], v6 offset:1024
  v_mfma_f32_16x16x32_bf16 v[64:67], v[128:131], v[120:123], v[64:67]
  ds_read_b128 v[156:159], v6 offset:3072
  v_mfma_f32_16x16x32_bf16 v[88:91], v[128:131], v[124:127], v[88:91]
  ds_read_b128 v[160:163], v6 offset:5120
  v_mfma_f32_16x16x32_bf16 v[92:95], v[132:135], v[124:127], v[92:95]
  ds_read_b128 v[164:167], v6 offset:7168
  v_mfma_f32_16x16x32_bf16 v[68:71], v[132:135], v[120:123], v[68:71]
  ds_read_b128 v[172:175], v7 offset:7168
  v_mfma_f32_16x16x32_bf16 v[44:47], v[132:135], v[116:119], v[44:47]
  ds_read_b128 v[176:179], v7 offset:8192
  v_mfma_f32_16x16x32_bf16 v[20:23], v[132:135], v[112:115], v[20:23]
  ds_read_b128 v[180:183], v7 offset:9216
  v_mfma_f32_16x16x32_bf16 v[24:27], v[136:139], v[112:115], v[24:27]
  ds_read_b128 v[184:187], v7 offset:10240
  v_mfma_f32_16x16x32_bf16 v[48:51], v[136:139], v[116:119], v[48:51]
  ds_read_b128 v[188:191], v7 offset:11264
  v_mfma_f32_16x16x32_bf16 v[72:75], v[136:139], v[120:123], v[72:75]
  s_add_u32 s22, s22, 45056
  v_mfma_f32_16x16x32_bf16 v[96:99], v[136:139], v[124:127], v[96:99]
  s_cmp_eq_u32 s22, 135168
  v_mfma_f32_16x16x32_bf16 v[100:103], v[140:143], v[124:127], v[100:103]
  s_cselect_b32 s22, 0, s22
  v_mfma_f32_16x16x32_bf16 v[76:79], v[140:143], v[120:123], v[76:79]
  v_add_u32 v6, s22, v3
  v_mfma_f32_16x16x32_bf16 v[52:55], v[140:143], v[116:119], v[52:55]
  v_add_u32 v7, s22, v4
  v_mfma_f32_16x16x32_bf16 v[28:31], v[140:143], v[112:115], v[28:31]
  v_mfma_f32_16x16x32_bf16 v[32:35], v[112:115], v[144:147], v[32:35]
  v_mfma_f32_16x16x32_bf16 v[56:59], v[116:119], v[144:147], v[56:59]
  v_mfma_f32_16x16x32_bf16 v[80:83], v[120:123], v[144:147], v[80:83]
  v_mfma_f32_16x16x32_bf16 v[104:107], v[124:127], v[144:147], v[104:107]
  v_mfma_f32_16x16x32_bf16 v[108:111], v[124:127], v[148:151], v[108:111]
  v_mfma_f32_16x16x32_bf16 v[84:87], v[120:123], v[148:151], v[84:87]
  v_mfma_f32_16x16x32_bf16 v[60:63], v[116:119], v[148:151], v[60:63]
  v_mfma_f32_16x16x32_bf16 v[36:39], v[112:115], v[148:151], v[36:39]
  s_waitcnt lgkmcnt(0)
  s_barrier
  v_mfma_f32_16x16x32_bf16 v[16:19], v[168:171], v[152:155], v[16:19]
  ds_read_b128 v[128:131], v7 offset:0
  v_mfma_f32_16x16x32_bf16 v[40:43], v[168:171], v[156:159], v[40:43]
  ds_read_b128 v[112:115], v6 offset:0
  v_mfma_f32_16x16x32_bf16 v[64:67], v[168:171], v[160:163], v[64:67]
  ds_read_b128 v[116:119], v6 offset:2048
  v_mfma_f32_16x16x32_bf16 v[88:91], v[168:171], v[164:167], v[88:91]
  ds_read_b128 v[120:123], v6 offset:4096
  v_mfma_f32_16x16x32_bf16 v[92:95], v[172:175], v[164:167], v[92:95]
  ds_read_b128 v[124:127], v6 offset:6144
  v_mfma_f32_16x16x32_bf16 v[68:71], v[172:175], v[160:163], v[68:71]
  ds_read_b128 v[132:135], v7 offset:1024
  v_mfma_f32_16x16x32_bf16 v[44:47], v[172:175], v[156:159], v[44:47]
  ds_read_b128 v[136:139], v7 offset:2048
  v_mfma_f32_16x16x32_bf16 v[20:23], v[172:175], v[152:155], v[20:23]
  ds_read_b128 v[140:143], v7 offset:3072
  v_mfma_f32_16x16x32_bf16 v[24:27], v[176:179], v[152:155], v[24:27]
  ds_read_b128 v[144:147], v7 offset:4096
  v_mfma_f32_16x16x32_bf16 v[48:51], v[176:179], v[156:159], v[48:51]
  ds_read_b128 v[148:151], v7 offset:5120
  v_mfma_f32_16x16x32_bf16 v[72:75], v[176:179], v[160:163], v[72:75]
  s_sub_u32 s23, s23, 2
  v_mfma_f32_16x16x32_bf16 v[96:99], v[176:179], v[164:167], v[96:99]
  s_cmp_lg_u32 s23, 0
  v_mfma_f32_16x16x32_bf16 v[100:103], v[180:183], v[164:167], v[100:103]
  v_mfma_f32_16x16x32_bf16 v[76:79], v[180:183], v[160:163], v[76:79]
  v_mfma_f32_16x16x32_bf16 v[52:55], v[180:183], v[156:159], v[52:55]
  v_mfma_f32_16x16x32_bf16 v[28:31], v[180:183], v[152:155], v[28:31]
  v_mfma_f32_16x16x32_bf16 v[32:35], v[152:155], v[184:187], v[32:35]
  v_mfma_f32_16x16x32_bf16 v[56:59], v[156:159], v[184:187], v[56:59]
  v_mfma_f32_16x16x32_bf16 v[80:83], v[160:163], v[184:187], v[80:83]
  v_mfma_f32_16x16x32_bf16 v[104:107], v[164:167], v[184:187], v[104:107]
  v_mfma_f32_16x16x32_bf16 v[108:111], v[164:167], v[188:191], v[108:111]
  v_mfma_f32_16x16x32_bf16 v[84:87], v[160:163], v[188:191], v[84:87]
  v_mfma_f32_16x16x32_bf16 v[60:63], v[156:159], v[188:191], v[60:63]
  v_mfma_f32_16x16x32_bf16 v[36:39], v[152:155], v[188:191], v[36:39]
  s_cbranch_scc1 qkv_loop
  s_waitcnt vmcnt(0) lgkmcnt(0)
  s_nop 7
  s_add_u32 s32, s4, 0x800000
  s_addc_u32 s33, s5, 0
  s_mov_b32 s34, 0x800000
  s_mov_b32 s35, 0x20000
  s_lshl_b32 s24, s10, 6
  s_lshr_b32 s25, s27, 1
  s_add_u32 s24, s24, s25
  s_lshl_b32 s25, s24, 12
  s_lshl_b32 s24, s8, 12
  s_add_u32 s24, s24, 0x18000
  s_add_u32 s26, s25, 4096
  v_lshlrev_b32 v9, 9, v2
  v_lshl_add_u32 v10, v1, 4, v9
  v_lshrrev_b32 v11, 3, v1
  v_lshlrev_b32 v11, 8, v11
  v_and_b32 v12, 7, v1
  v_lshl_add_u32 v11, v12, 4, v11
  v_add_u32 v11, v11, v9
  s_mov_b32 s44, 0x3e8293ee
  s_mov_b32 s45, s44
  v_add_u32 v13, s24, v10
  v_cvt_pk_bf16_f32 v112, v24, v25
  v_cvt_pk_bf16_f32 v113, v26, v27
  v_cvt_pk_bf16_f32 v114, v28, v29
  v_cvt_pk_bf16_f32 v115, v30, v31
  buffer_store_dwordx4 v[112:115], v11, s[32:35], s25 offen offset:0 sc1
  v_cvt_pk_bf16_f32 v116, v48, v49
  v_cvt_pk_bf16_f32 v117, v50, v51
  v_cvt_pk_bf16_f32 v118, v52, v53
  v_cvt_pk_bf16_f32 v119, v54, v55
  buffer_store_dwordx4 v[116:119], v11, s[32:35], s25 offen offset:128 sc1
  v_cvt_pk_bf16_f32 v120, v72, v73
  v_cvt_pk_bf16_f32 v121, v74, v75
  v_cvt_pk_bf16_f32 v122, v76, v77
  v_cvt_pk_bf16_f32 v123, v78, v79
  buffer_store_dwordx4 v[120:123], v11, s[32:35], s26 offen offset:0 sc1
  v_cvt_pk_bf16_f32 v124, v96, v97
  v_cvt_pk_bf16_f32 v125, v98, v99
  v_cvt_pk_bf16_f32 v126, v100, v101
  v_cvt_pk_bf16_f32 v127, v102, v103
  buffer_store_dwordx4 v[124:127], v11, s[32:35], s26 offen offset:128 sc1
  v_cvt_pk_bf16_f32 v128, v32, v33
  v_cvt_pk_bf16_f32 v129, v34, v35
  v_cvt_pk_bf16_f32 v130, v56, v57
  v_cvt_pk_bf16_f32 v131, v58, v59
  buffer_store_dwordx4 v[128:131], v10, s[32:35], s25 offen offset:2048 sc1
  v_cvt_pk_bf16_f32 v132, v36, v37
  v_cvt_pk_bf16_f32 v133, v38, v39
  v_cvt_pk_bf16_f32 v134, v60, v61
  v_cvt_pk_bf16_f32 v135, v62, v63
  buffer_store_dwordx4 v[132:135], v10, s[32:35], s25 offen offset:2304 sc1
  v_cvt_pk_bf16_f32 v136, v80, v81
  v_cvt_pk_bf16_f32 v137, v82, v83
  v_cvt_pk_bf16_f32 v138, v104, v105
  v_cvt_pk_bf16_f32 v139, v106, v107
  buffer_store_dwordx4 v[136:139], v10, s[32:35], s26 offen offset:2048 sc1
  v_cvt_pk_bf16_f32 v140, v84, v85
  v_cvt_pk_bf16_f32 v141, v86, v87
  v_cvt_pk_bf16_f32 v142, v108, v109
  v_cvt_pk_bf16_f32 v143, v110, v111
  buffer_store_dwordx4 v[140:143], v10, s[32:35], s26 offen offset:2304 sc1
  v_pk_mul_f32 v[16:17], v[16:17], s[44:45]
  v_pk_mul_f32 v[18:19], v[18:19], s[44:45]
  v_pk_mul_f32 v[20:21], v[20:21], s[44:45]
  v_pk_mul_f32 v[22:23], v[22:23], s[44:45]
  v_cvt_pk_bf16_f32 v144, v16, v17
  v_cvt_pk_bf16_f32 v145, v18, v19
  v_cvt_pk_bf16_f32 v146, v20, v21
  v_cvt_pk_bf16_f32 v147, v22, v23
  ds_write_b128 v13, v[144:147] offset:0
  v_pk_mul_f32 v[40:41], v[40:41], s[44:45]
  v_pk_mul_f32 v[42:43], v[42:43], s[44:45]
  v_pk_mul_f32 v[44:45], v[44:45], s[44:45]
  v_pk_mul_f32 v[46:47], v[46:47], s[44:45]
  v_cvt_pk_bf16_f32 v148, v40, v41
  v_cvt_pk_bf16_f32 v149, v42, v43
  v_cvt_pk_bf16_f32 v150, v44, v45
  v_cvt_pk_bf16_f32 v151, v46, v47
  ds_write_b128 v13, v[148:151] offset:256
  v_pk_mul_f32 v[64:65], v[64:65], s[44:45]
  v_pk_mul_f32 v[66:67], v[66:67], s[44:45]
  v_pk_mul_f32 v[68:69], v[68:69], s[44:45]
  v_pk_mul_f32 v[70:71], v[70:71], s[44:45]
  v_cvt_pk_bf16_f32 v152, v64, v65
  v_cvt_pk_bf16_f32 v153, v66, v67
  v_cvt_pk_bf16_f32 v154, v68, v69
  v_cvt_pk_bf16_f32 v155, v70, v71
  ds_write_b128 v13, v[152:155] offset:2048
  v_pk_mul_f32 v[88:89], v[88:89], s[44:45]
  v_pk_mul_f32 v[90:91], v[90:91], s[44:45]
  v_pk_mul_f32 v[92:93], v[92:93], s[44:45]
  v_pk_mul_f32 v[94:95], v[94:95], s[44:45]
  v_cvt_pk_bf16_f32 v156, v88, v89
  v_cvt_pk_bf16_f32 v157, v90, v91
  v_cvt_pk_bf16_f32 v158, v92, v93
  v_cvt_pk_bf16_f32 v159, v94, v95
  ds_write_b128 v13, v[156:159] offset:2304
qkv_done:
  s_mov_b64 exec, -1
attn:
  s_and_b32 s24, s2, 7
  s_mov_b32 s8, s62
  s_lshr_b32 s25, s2, 3
  s_lshl_b32 s9, s24, 2
  s_lshr_b32 s26, s25, 3
  s_add_u32 s9, s9, s26
  s_and_b32 s25, s25, 7
  s_and_b32 s3, s8, 3
  s_lshr_b32 s11, s8, 2
  s_lshl_b32 s10, s25, 2
  s_add_u32 s10, s10, s3
  v_lshlrev_b32 v2, 4, v0
  s_lshl_b32 s44, s8, 12
  s_lshl_b32 s45, s11, 14
  v_add_u32 v4, s45, v2
  s_mov_b32 s40, 0
  s_cmp_eq_u32 s8, 0
  s_cselect_b32 s41, 1, 0
  s_cmp_lt_u32 s2, 112
  s_cselect_b32 s43, 2, 0
  s_mov_b32 s60, 0
  s_mov_b32 s61, 0
  s_mov_b32 s15, 0x20000
  s_lshl_b32 s24, s9, 18
  s_add_u32 s24, s24, 0x800000
  s_add_u32 s12, s4, s24
  s_addc_u32 s13, s5, 0
  s_mov_b32 s14, 0x40000
  s_lshl_b32 s25, s11, 17
  s_lshl_b32 s26, s3, 12
  s_add_u32 s25, s25, s26
  v_add_u32 v3, s25, v2
  s_movk_i32 s58, 0x4000
  s_cmp_lt_u32 s2, 112
  s_cbranch_scc0 attn_rt2
  s_mov_b32 s28, s92
  s_mov_b32 s29, s93
  s_mov_b32 s30, 0x700000
  s_mov_b32 s31, 0x20000
  s_add_u32 s32, s4, 0x3800000
  s_addc_u32 s33, s5, 0
  s_mov_b32 s34, 0x700000
  s_mov_b32 s35, 0x20000
  s_movk_i32 s56, 7168
  s_mul_i32 s60, s2, 4682
  s_lshr_b32 s60, s60, 16
  s_mul_i32 s25, s60, 14
  s_sub_u32 s25, s2, s25
  s_lshl_b32 s61, s25, 3
  s_add_u32 s61, s61, s8
  s_mul_i32 s50, s60, 917504
  s_lshl_b32 s24, s61, 6
  s_add_u32 s50, s50, s24
  s_mov_b32 s51, 229376
  s_mov_b32 s52, 114688
  s_mul_i32 s24, s61, 9363
  s_lshr_b32 s24, s24, 16
  s_mul_i32 s25, s24, 7
  s_sub_u32 s25, s61, s25
  s_lshl_b32 s24, s24, 5
  s_lshl_b32 s26, s60, 2
  s_add_u32 s24, s24, s26
  s_mul_i32 s24, s24, 7
  s_add_u32 s24, s24, s25
  s_lshl_b32 s53, s24, 11
  s_movk_i32 s54, 14336
  s_movk_i32 s55, 14336
  v_lshrrev_b32 v11, 4, v0
  v_bfe_u32 v12, v0, 2, 2
  v_and_b32 v13, 1, v11
  v_and_b32 v14, 3, v0
  v_lshlrev_b32 v15, 1, v13
  v_xor_b32 v14, v14, v15
  v_lshl_add_u32 v10, v11, 2, v12
  v_mul_lo_u32 v10, v10, s56
  v_lshl_add_u32 v10, v14, 4, v10
  s_branch attn_rt9
attn_rt2:
  s_movk_i32 s56, 2048
  s_movk_i32 s51, 64
  s_movk_i32 s54, 2048
  s_mov_b32 s28, s96
  s_mov_b32 s29, s97
  s_mov_b32 s30, 0x700000
  s_mov_b32 s31, 0x20000
  s_add_u32 s32, s4, 0x4000000
  s_addc_u32 s33, s5, 0
  s_mov_b32 s34, 0x700000
  s_mov_b32 s35, 0x20000
  s_sub_u32 s26, s2, 112
  s_mul_i32 s53, s8, 917504
  s_mov_b32 s55, 456704
  s_mul_i32 s24, s26, 9363
  s_lshr_b32 s24, s24, 16
  s_mul_i32 s25, s24, 7
  s_sub_u32 s25, s26, s25
  s_cmp_eq_u32 s25, 3
  s_cbranch_scc1 attn_rt2n
  s_mov_b32 s52, 32768
  v_lshrrev_b32 v11, 4, v0
  v_bfe_u32 v12, v0, 2, 2
  v_and_b32 v13, 1, v11
  v_and_b32 v14, 3, v0
  v_lshlrev_b32 v15, 1, v13
  v_xor_b32 v14, v14, v15
  v_lshl_add_u32 v10, v11, 2, v12
  v_mul_lo_u32 v10, v10, s56
  v_lshl_add_u32 v10, v14, 4, v10
  s_branch attn_rt8
attn_rt2n:
  s_movk_i32 s52, 8192
  v_lshrrev_b32 v11, 4, v0
  v_bfe_u32 v12, v0, 2, 2
  v_and_b32 v13, 1, v11
  v_and_b32 v14, 3, v0
  v_lshlrev_b32 v15, 1, v13
  v_xor_b32 v14, v14, v15
  v_lshl_add_u32 v10, v11, 3, v12
  v_mul_lo_u32 v10, v10, s56
  v_lshl_add_u32 v10, v14, 4, v10
attn_rt8:
  s_lshl_b32 s50, s26, 16
  s_lshl_b32 s24, s8, 8
  s_add_u32 s50, s50, s24
  s_lshl_b32 s24, s26, 12
  s_add_u32 s53, s53, s24
  s_cmp_lt_u32 s2, 224
  s_cselect_b32 s50, s50, 0x7f000000
  s_cselect_b32 s53, s53, 0x7f000000
attn_rt9:
  s_add_u32 s57, s44, 131072
  v_lshrrev_b32 v12, 2, v0
  v_lshlrev_b32 v12, 6, v12
  v_and_b32 v11, 3, v0
  v_lshl_add_u32 v12, v11, 3, v12
  v_bfe_u32 v11, v0, 4, 1
  v_lshl_add_u32 v12, v11, 5, v12
  v_add_u32 v12, s57, v12
  v_xor_b32 v13, 32, v12
  v_mov_b32 v212, 0
  v_mov_b32 v213, 0
  v_mov_b32 v214, 0
  v_mov_b32 v215, 0
  v_mov_b32 v216, 0
  v_mov_b32 v217, 0
  v_mov_b32 v218, 0
  v_mov_b32 v219, 0
  v_mov_b32 v220, 0x3f803f80
  v_mov_b32 v221, 0x3f803f80
  v_mov_b32 v222, 0x3f803f80
  v_mov_b32 v223, 0x3f803f80
  s_sub_u32 s53, s53, s54
  s_sub_u32 s53, s53, s55
  v_add_u32 v11, s57, v2
  ds_write_b128 v11, v[212:215] offset:2048
  ds_write_b128 v11, v[212:215] offset:3072
  v_xor_b32 v12, 0x800, v12
  v_xor_b32 v13, 0x800, v13
  v_lshrrev_b32 v8, 4, v0
  v_lshrrev_b32 v5, 2, v0
  v_xor_b32 v8, v8, v5
  v_and_b32 v8, 1, v8
  v_cmp_eq_u32 vcc, 0, v8
  v_mov_b32 v5, 0x3f803f80
  s_nop 1
  v_cndmask_b32 v200, 0, v5, vcc
  v_cndmask_b32 v201, 0, v5, vcc
  v_cndmask_b32 v202, 0, v5, vcc
  v_cndmask_b32 v203, 0, v5, vcc
  v_and_b32 v8, 4, v0
  v_cmp_eq_u32 vcc, 0, v8
  s_nop 1
  v_cndmask_b32 v228, 0, v5, vcc
  v_cndmask_b32 v229, 0, v5, vcc
  v_xor_b32 v230, v228, v5
  v_xor_b32 v231, v228, v5
  v_and_b32 v8, 1, v0
  v_cmp_eq_u32 vcc, 0, v8
  v_mov_b32 v1, 0xeeeeeeee
  v_mov_b32 v5, 0x44444444
  v_cndmask_b32 v1, v1, v5, vcc
  v_mov_b32 v48, 0
  v_mov_b32 v49, 0
  v_mov_b32 v50, 0
  v_mov_b32 v51, 0
  v_mov_b32 v52, 0
  v_mov_b32 v53, 0
  v_mov_b32 v54, 0
  v_mov_b32 v55, 0
  v_mov_b32 v56, 0
  v_mov_b32 v57, 0
  v_mov_b32 v58, 0
  v_mov_b32 v59, 0
  v_mov_b32 v60, 0
  v_mov_b32 v61, 0
  v_mov_b32 v62, 0
  v_mov_b32 v63, 0
  v_mov_b32 v64, 0
  v_mov_b32 v65, 0
  v_mov_b32 v66, 0
  v_mov_b32 v67, 0
  v_mov_b32 v96, 0
  v_mov_b32 v97, 0
  v_mov_b32 v98, 0
  v_mov_b32 v99, 0
  v_mov_b32 v132, 0
  v_mov_b32 v133, 0
  v_mov_b32 v134, 0
  v_mov_b32 v135, 0
  v_mov_b32 v136, 0
  v_mov_b32 v137, 0
  v_mov_b32 v138, 0
  v_mov_b32 v139, 0
  v_mov_b32 v140, 0
  v_mov_b32 v141, 0
  v_mov_b32 v142, 0
  v_mov_b32 v143, 0
  v_mov_b32 v144, 0
  v_mov_b32 v145, 0
  v_mov_b32 v146, 0
  v_mov_b32 v147, 0
  v_mov_b32 v148, 0
  v_mov_b32 v149, 0
  v_mov_b32 v150, 0
  v_mov_b32 v151, 0
  v_mov_b32 v180, 0
  v_mov_b32 v181, 0
  v_mov_b32 v182, 0
  v_mov_b32 v183, 0
  v_mov_b32 v196, 0
  v_mov_b32 v197, 0
  v_mov_b32 v198, 0
  v_mov_b32 v199, 0
  v_mov_b32 v6, v4
  v_add_u32 v7, 0x8000, v4
  s_mov_b32 s23, 8
  s_mov_b32 s21, 0x8000
  s_nop 0
  s_lshl_b32 s24, s9, 10
  s_add_u32 s24, s24, 0
  s_and_b32 s25, s2, 4
  s_lshr_b32 s26, s2, 6
  s_add_u32 s25, s25, s26
  v_and_b32 v16, 7, v0
  v_lshl_add_u32 v16, v16, 7, s24
  v_and_b32 v17, 31, v0
  v_lshl_add_u32 v17, v17, 3, s25
  v_lshlrev_b32 v17, 7, v17
  v_cmp_gt_u32 vcc, 32, v0
  v_add_u32 v17, 229376, v17
  s_mov_b32 s24, 0
  v_cndmask_b32 v16, v17, v16, vcc
  s_waitcnt vmcnt(0) lgkmcnt(0)
  s_add_u32 s36, s4, 0x2a00000
  s_addc_u32 s37, s5, 0
  s_mov_b32 s38, 0x40000
  s_mov_b32 s39, 0x20000
  s_barrier
  s_cmp_eq_u32 s62, 4
  s_cbranch_scc0 ho5a
  v_mov_b32 v18, 0
  v_mov_b32 v19, 1
  s_mov_b64 exec, 1
  buffer_store_dword v19, v18, s[36:39], s42 offen sc1
  s_mov_b64 exec, -1
ho5a:
  s_cmp_eq_u32 s62, 7
  s_cbranch_scc0 ho5
  s_mov_b32 s63, 0x40000
poll6:
  buffer_load_dword v20, v16, s[36:39], s24 offen sc1
  s_sub_u32 s63, s63, 1
  s_waitcnt vmcnt(0)
  v_cmp_eq_u32 vcc, 0, v20
  s_nop 3
  s_cbranch_scc1 poll6x
  s_cbranch_vccz poll6x
  s_sleep 2
  s_branch poll6
poll6x:
ho5:
  s_barrier
  s_mov_b32 s20, 0
  s_mov_b32 s22, 0
  s_add_u32 m0, s22, s44
  s_add_u32 s22, s22, 0x8000
  buffer_load_dwordx4 v3, s[12:15], s20 offen offset:0 sc1 lds
  buffer_load_dwordx4 v3, s[12:15], s20 offen offset:1024 sc1 lds
  buffer_load_dwordx4 v3, s[12:15], s20 offen offset:2048 sc1 lds
  buffer_load_dwordx4 v3, s[12:15], s20 offen offset:3072 sc1 lds
  s_add_u32 s20, s20, 0x4000
  s_and_b32 s22, s22, 0x1ffff
  s_add_u32 m0, s22, s44
  s_add_u32 s22, s22, 0x8000
  buffer_load_dwordx4 v3, s[12:15], s20 offen offset:0 sc1 lds
  buffer_load_dwordx4 v3, s[12:15], s20 offen offset:1024 sc1 lds
  buffer_load_dwordx4 v3, s[12:15], s20 offen offset:2048 sc1 lds
  buffer_load_dwordx4 v3, s[12:15], s20 offen offset:3072 sc1 lds
  s_add_u32 s20, s20, 0x4000
  s_and_b32 s22, s22, 0x1ffff
  s_add_u32 s16, s4, 0x1000000
  s_addc_u32 s17, s5, 0
  s_mov_b32 s18, 0x400000
  s_mov_b32 s19, 0x20000
  s_lshl_b32 s24, s3, 12
  s_add_u32 s24, s24, 0x18000
  v_add_u32 v8, s24, v2
  ds_read_b128 v[84:87], v8 offset:0
  ds_read_b128 v[88:91], v8 offset:1024
  ds_read_b128 v[168:171], v8 offset:2048
  ds_read_b128 v[172:175], v8 offset:3072
attn_restart:
  s_waitcnt vmcnt(4)
  s_barrier
  ds_read_b128 v[204:207], v2
  ds_read_b128 v[208:211], v2 offset:1024
  ds_read_b128 v[184:187], v6
  ds_read_b128 v[188:191], v6 offset:1024
  s_cmp_lg_u32 s40, 0
  s_cbranch_scc1 attn_havemax
  s_waitcnt lgkmcnt(2)
  v_mfma_f32_32x32x16_bf16 v[16:31], v[204:207], v[84:87], 0
  v_mfma_f32_32x32x16_bf16 v[100:115], v[204:207], v[168:171], 0
  v_mfma_f32_32x32x16_bf16 v[16:31], v[208:211], v[88:91], v[16:31]
  v_mfma_f32_32x32x16_bf16 v[100:115], v[208:211], v[172:175], v[100:115]
  s_nop 11
  v_max3_f32 v14, v16, v17, v18
  v_max3_f32 v14, v19, v20, v14
  v_max3_f32 v14, v21, v22, v14
  v_max3_f32 v14, v23, v24, v14
  v_max3_f32 v14, v25, v26, v14
  v_max3_f32 v14, v27, v28, v14
  v_max3_f32 v14, v29, v30, v14
  v_max_f32 v14, v31, v14
  v_max3_f32 v15, v100, v101, v102
  v_max3_f32 v15, v103, v104, v15
  v_max3_f32 v15, v105, v106, v15
  v_max3_f32 v15, v107, v108, v15
  v_max3_f32 v15, v109, v110, v15
  v_max3_f32 v15, v111, v112, v15
  v_max3_f32 v15, v113, v114, v15
  v_max_f32 v15, v115, v15
  v_mov_b32 v8, v14
  v_mov_b32 v9, v15
  s_nop 1
  v_permlane32_swap_b32 v14, v8
  v_permlane32_swap_b32 v15, v9
  s_nop 1
  v_max_f32 v14, v14, v8
  v_max_f32 v15, v15, v9
attn_havemax:
  s_add_u32 m0, s22, s44
  s_add_u32 s22, s22, 0x8000
  v_sub_f32 v68, 0, v14
  buffer_load_dwordx4 v3, s[12:15], s20 offen offset:0 sc1 lds
  v_sub_f32 v69, 0, v14
  v_sub_f32 v70, 0, v14
  v_sub_f32 v71, 0, v14
  v_sub_f32 v72, 0, v14
  v_sub_f32 v73, 0, v14
  v_sub_f32 v74, 0, v14
  v_sub_f32 v75, 0, v14
  v_sub_f32 v76, 0, v14
  buffer_load_dwordx4 v3, s[12:15], s20 offen offset:1024 sc1 lds
  v_sub_f32 v77, 0, v14
  v_sub_f32 v78, 0, v14
  v_sub_f32 v79, 0, v14
  v_sub_f32 v80, 0, v14
  v_sub_f32 v81, 0, v14
  v_sub_f32 v82, 0, v14
  v_sub_f32 v83, 0, v14
  v_sub_f32 v152, 0, v15
  buffer_load_dwordx4 v3, s[12:15], s20 offen offset:2048 sc1 lds
  v_sub_f32 v153, 0, v15
  v_sub_f32 v154, 0, v15
  v_sub_f32 v155, 0, v15
  v_sub_f32 v156, 0, v15
  v_sub_f32 v157, 0, v15
  v_sub_f32 v158, 0, v15
  v_sub_f32 v159, 0, v15
  v_sub_f32 v160, 0, v15
  buffer_load_dwordx4 v3, s[12:15], s20 offen offset:3072 sc1 lds
  v_sub_f32 v161, 0, v15
  v_sub_f32 v162, 0, v15
  v_sub_f32 v163, 0, v15
  v_sub_f32 v164, 0, v15
  v_sub_f32 v165, 0, v15
  v_sub_f32 v166, 0, v15
  v_sub_f32 v167, 0, v15
  s_add_u32 s20, s20, 0x4000
  s_and_b32 s22, s22, 0x1ffff
  s_waitcnt lgkmcnt(0)
  v_mov_b32 v204, 0
  v_mov_b32 v205, 0
  v_mov_b32 v206, 0
  v_mov_b32 v207, 0
  v_mov_b32 v208, 0
  v_mov_b32 v209, 0
  v_mov_b32 v210, 0
  v_mov_b32 v211, 0
  v_mfma_f32_32x32x16_bf16 v[16:31], v[184:187], v[84:87], v[68:83]
  v_mfma_f32_32x32x16_bf16 v[100:115], v[184:187], v[168:171], v[152:167]
  v_mfma_f32_32x32x16_bf16 v[16:31], v[188:191], v[88:91], v[16:31]
  v_mfma_f32_32x32x16_bf16 v[100:115], v[188:191], v[172:175], v[100:115]
  ds_read_b128 v[184:187], v6 offset:4096
  ds_read_b128 v[188:191], v6 offset:5120
  ds_read_b128 v[192:195], v6 offset:2048
  s_waitcnt vmcnt(4) lgkmcnt(0)
  s_nop 7
  .p2align 5
attn_loop:
  s_cmp_eq_u32 s23, s43
  s_cbranch_scc1 attn_cs
attn_csr:
  s_setprio 1
  s_waitcnt lgkmcnt(2)
  v_mfma_f32_32x32x16_bf16 v[32:47], v[184:187], v[84:87], v[68:83]
  v_exp_f32 v16, v16
  v_exp_f32 v17, v17
  v_exp_f32 v18, v18
  v_exp_f32 v19, v19
  v_mfma_f32_32x32x16_bf16 v[116:131], v[184:187], v[168:171], v[152:167]
  ds_read_b128 v[184:187], v6 offset:8192
  v_exp_f32 v20, v20
  v_exp_f32 v21, v21
  v_exp_f32 v22, v22
  v_exp_f32 v23, v23
  v_mfma_f32_32x32x16_bf16 v[48:63], v[196:199], v[96:99], v[48:63]
  s_sub_u32 s24, s23, 3
  s_cmp_lt_u32 s24, 4
  s_cselect_b32 s25, s53, 0x7f000000
  buffer_store_dwordx4 v[204:207], v2, s[32:35], s25 offen sc1
  v_cvt_pk_bf16_f32 v92, v16, v17
  v_cvt_pk_bf16_f32 v93, v18, v19
  v_cvt_pk_bf16_f32 v94, v20, v21
  v_cvt_pk_bf16_f32 v95, v22, v23
  v_exp_f32 v100, v100
  v_exp_f32 v101, v101
  v_mfma_f32_32x32x16_bf16 v[132:147], v[196:199], v[180:183], v[132:147]
  ds_read_b128 v[196:199], v6 offset:3072
  v_exp_f32 v102, v102
  v_exp_f32 v103, v103
  v_exp_f32 v104, v104
  v_exp_f32 v105, v105
  v_mfma_f32_16x16x32_bf16 v[212:215], v[204:207], v[220:223], v[212:215]
  s_add_u32 s53, s53, s54
  s_mov_b32 s24, s54
  v_smfmac_f32_16x16x64_bf16 v[64:67], v[228:231], v[92:99], v1
  v_exp_f32 v106, v106
  v_exp_f32 v107, v107
  v_cvt_pk_bf16_f32 v176, v100, v101
  v_cvt_pk_bf16_f32 v177, v102, v103
  v_cvt_pk_bf16_f32 v178, v104, v105
  v_cvt_pk_bf16_f32 v179, v106, v107
  s_waitcnt lgkmcnt(2)
  v_mfma_f32_32x32x16_bf16 v[32:47], v[188:191], v[88:91], v[32:47]
  v_exp_f32 v24, v24
  v_exp_f32 v25, v25
  v_exp_f32 v26, v26
  v_exp_f32 v27, v27
  v_mfma_f32_32x32x16_bf16 v[116:131], v[188:191], v[172:175], v[116:131]
  ds_read_b128 v[188:191], v6 offset:9216
  v_exp_f32 v28, v28
  v_exp_f32 v29, v29
  v_exp_f32 v30, v30
  v_exp_f32 v31, v31
  v_mfma_f32_32x32x16_bf16 v[48:63], v[192:195], v[92:95], v[48:63]
  s_mov_b32 s54, s55
  s_mov_b32 s55, s24
  buffer_store_dwordx4 v[208:211], v2, s[32:35], s25 offen offset:1024 sc1
  v_cvt_pk_bf16_f32 v96, v24, v25
  v_cvt_pk_bf16_f32 v97, v26, v27
  v_cvt_pk_bf16_f32 v98, v28, v29
  v_cvt_pk_bf16_f32 v99, v30, v31
  v_exp_f32 v108, v108
  v_exp_f32 v109, v109
  v_mfma_f32_32x32x16_bf16 v[132:147], v[192:195], v[176:179], v[132:147]
  ds_read_b128 v[192:195], v6 offset:6144
  v_exp_f32 v110, v110
  v_exp_f32 v111, v111
  v_exp_f32 v112, v112
  v_exp_f32 v113, v113
  v_mfma_f32_16x16x32_bf16 v[216:219], v[208:211], v[220:223], v[216:219]
  v_smfmac_f32_16x16x64_bf16 v[148:151], v[228:231], v[176:183], v1
  v_exp_f32 v114, v114
  v_exp_f32 v115, v115
  v_cvt_pk_bf16_f32 v180, v108, v109
  v_cvt_pk_bf16_f32 v181, v110, v111
  v_cvt_pk_bf16_f32 v182, v112, v113
  v_cvt_pk_bf16_f32 v183, v114, v115
  s_cmp_eq_u32 s23, 3
  s_cbranch_scc1 attn_sw
attn_swr:
  s_setprio 0
  s_waitcnt lgkmcnt(2)
  v_mfma_f32_32x32x16_bf16 v[16:31], v[184:187], v[84:87], v[68:83]
  v_exp_f32 v32, v32
  v_exp_f32 v33, v33
  v_exp_f32 v34, v34
  v_exp_f32 v35, v35
  v_mfma_f32_32x32x16_bf16 v[100:115], v[184:187], v[168:171], v[152:167]
  ds_read_b128 v[184:187], v6 offset:12288
  v_exp_f32 v36, v36
  v_exp_f32 v37, v37
  v_exp_f32 v38, v38
  v_exp_f32 v39, v39
  v_mfma_f32_32x32x16_bf16 v[48:63], v[196:199], v[96:99], v[48:63]
  s_cmp_gt_u32 s23, 4
  s_mov_b32 m0, s57
  s_cselect_b32 s25, s50, 0x7f000000
  buffer_load_dwordx4 v10, s[28:31], s25 offen nt lds
  v_cvt_pk_bf16_f32 v92, v32, v33
  v_cvt_pk_bf16_f32 v93, v34, v35
  v_cvt_pk_bf16_f32 v94, v36, v37
  v_cvt_pk_bf16_f32 v95, v38, v39
  v_exp_f32 v116, v116
  v_exp_f32 v117, v117
  v_mfma_f32_32x32x16_bf16 v[132:147], v[196:199], v[180:183], v[132:147]
  ds_read_b128 v[196:199], v6 offset:7168
  v_exp_f32 v118, v118
  v_exp_f32 v119, v119
  v_exp_f32 v120, v120
  v_exp_f32 v121, v121
  v_smfmac_f32_16x16x64_bf16 v[64:67], v[228:231], v[92:99], v1
  v_exp_f32 v122, v122
  v_exp_f32 v123, v123
  v_cvt_pk_bf16_f32 v176, v116, v117
  v_cvt_pk_bf16_f32 v177, v118, v119
  v_cvt_pk_bf16_f32 v178, v120, v121
  v_cvt_pk_bf16_f32 v179, v122, v123
  s_waitcnt lgkmcnt(2)
  v_mfma_f32_32x32x16_bf16 v[16:31], v[188:191], v[88:91], v[16:31]
  v_exp_f32 v40, v40
  v_exp_f32 v41, v41
  v_exp_f32 v42, v42
  v_exp_f32 v43, v43
  v_mfma_f32_32x32x16_bf16 v[100:115], v[188:191], v[172:175], v[100:115]
  ds_read_b128 v[188:191], v6 offset:13312
  v_exp_f32 v44, v44
  v_exp_f32 v45, v45
  v_exp_f32 v46, v46
  v_exp_f32 v47, v47
  v_mfma_f32_32x32x16_bf16 v[48:63], v[192:195], v[92:95], v[48:63]
  s_add_u32 m0, s57, 1024
  s_add_u32 s25, s25, s52
  buffer_load_dwordx4 v10, s[28:31], s25 offen nt lds
  v_cvt_pk_bf16_f32 v96, v40, v41
  v_cvt_pk_bf16_f32 v97, v42, v43
  v_cvt_pk_bf16_f32 v98, v44, v45
  v_cvt_pk_bf16_f32 v99, v46, v47
  v_exp_f32 v124, v124
  v_exp_f32 v125, v125
  v_mfma_f32_32x32x16_bf16 v[132:147], v[192:195], v[176:179], v[132:147]
  ds_read_b128 v[192:195], v6 offset:10240
  v_exp_f32 v126, v126
  v_exp_f32 v127, v127
  v_exp_f32 v128, v128
  v_exp_f32 v129, v129
  s_add_u32 s50, s50, s51
  s_xor_b32 s57, s57, 0x800
  v_smfmac_f32_16x16x64_bf16 v[148:151], v[228:231], v[176:183], v1
  v_exp_f32 v130, v130
  v_exp_f32 v131, v131
  v_cvt_pk_bf16_f32 v180, v124, v125
  v_cvt_pk_bf16_f32 v181, v126, v127
  v_cvt_pk_bf16_f32 v182, v128, v129
  v_cvt_pk_bf16_f32 v183, v130, v131
  s_waitcnt vmcnt(8)
  s_barrier
  s_cmp_eq_u32 s23, s41
  s_cbranch_scc1 attn_wf
attn_wfr:
  s_setprio 3
  s_waitcnt lgkmcnt(2)
  v_mfma_f32_32x32x16_bf16 v[32:47], v[184:187], v[84:87], v[68:83]
  v_exp_f32 v16, v16
  v_exp_f32 v17, v17
  v_exp_f32 v18, v18
  v_exp_f32 v19, v19
  v_mfma_f32_32x32x16_bf16 v[116:131], v[184:187], v[168:171], v[152:167]
  ds_read_b128 v[184:187], v7 offset:0
  v_exp_f32 v20, v20
  v_exp_f32 v21, v21
  v_exp_f32 v22, v22
  v_exp_f32 v23, v23
  v_mfma_f32_32x32x16_bf16 v[48:63], v[196:199], v[96:99], v[48:63]
  s_add_u32 m0, s22, s44
  s_add_u32 s22, s22, 0x8000
  s_and_b32 s22, s22, 0x1ffff
  v_cvt_pk_bf16_f32 v92, v16, v17
  v_cvt_pk_bf16_f32 v93, v18, v19
  v_cvt_pk_bf16_f32 v94, v20, v21
  v_cvt_pk_bf16_f32 v95, v22, v23
  v_exp_f32 v100, v100
  v_exp_f32 v101, v101
  v_mfma_f32_32x32x16_bf16 v[132:147], v[196:199], v[180:183], v[132:147]
  ds_read_b128 v[196:199], v6 offset:11264
  v_exp_f32 v102, v102
  v_exp_f32 v103, v103
  v_exp_f32 v104, v104
  v_exp_f32 v105, v105
  buffer_load_dwordx4 v3, s[12:15], s20 offen offset:0 sc1 lds
  v_smfmac_f32_16x16x64_bf16 v[64:67], v[228:231], v[92:99], v1
  v_exp_f32 v106, v106
  v_exp_f32 v107, v107
  v_cvt_pk_bf16_f32 v176, v100, v101
  v_cvt_pk_bf16_f32 v177, v102, v103
  v_cvt_pk_bf16_f32 v178, v104, v105
  v_cvt_pk_bf16_f32 v179, v106, v107
  s_waitcnt lgkmcnt(2)
  v_mfma_f32_32x32x16_bf16 v[32:47], v[188:191], v[88:91], v[32:47]
  v_exp_f32 v24, v24
  v_exp_f32 v25, v25
  v_exp_f32 v26, v26
  v_exp_f32 v27, v27
  v_mfma_f32_32x32x16_bf16 v[116:131], v[188:191], v[172:175], v[116:131]
  ds_read_b128 v[188:191], v7 offset:1024
  v_exp_f32 v28, v28
  v_exp_f32 v29, v29
  v_exp_f32 v30, v30
  v_exp_f32 v31, v31
  v_mfma_f32_32x32x16_bf16 v[48:63], v[192:195], v[92:95], v[48:63]
  v_cvt_pk_bf16_f32 v96, v24, v25
  v_cvt_pk_bf16_f32 v97, v26, v27
  v_cvt_pk_bf16_f32 v98, v28, v29
  v_cvt_pk_bf16_f32 v99, v30, v31
  v_exp_f32 v108, v108
  v_exp_f32 v109, v109
  v_mfma_f32_32x32x16_bf16 v[132:147], v[192:195], v[176:179], v[132:147]
  ds_read_b128 v[192:195], v6 offset:14336
  v_exp_f32 v110, v110
  v_exp_f32 v111, v111
  v_exp_f32 v112, v112
  v_exp_f32 v113, v113
  buffer_load_dwordx4 v3, s[12:15], s20 offen offset:1024 sc1 lds
  v_smfmac_f32_16x16x64_bf16 v[148:151], v[228:231], v[176:183], v1
  v_exp_f32 v114, v114
  v_exp_f32 v115, v115
  v_cvt_pk_bf16_f32 v180, v108, v109
  v_cvt_pk_bf16_f32 v181, v110, v111
  v_cvt_pk_bf16_f32 v182, v112, v113
  v_cvt_pk_bf16_f32 v183, v114, v115
  s_setprio 2
  s_waitcnt lgkmcnt(2)
  v_mfma_f32_32x32x16_bf16 v[16:31], v[184:187], v[84:87], v[68:83]
  v_exp_f32 v32, v32
  v_exp_f32 v33, v33
  v_exp_f32 v34, v34
  v_exp_f32 v35, v35
  v_mfma_f32_32x32x16_bf16 v[100:115], v[184:187], v[168:171], v[152:167]
  ds_read_b128 v[184:187], v7 offset:4096
  v_exp_f32 v36, v36
  v_exp_f32 v37, v37
  v_exp_f32 v38, v38
  v_exp_f32 v39, v39
  v_mfma_f32_32x32x16_bf16 v[48:63], v[196:199], v[96:99], v[48:63]
  buffer_load_dwordx4 v3, s[12:15], s20 offen offset:2048 sc1 lds
  v_cvt_pk_bf16_f32 v92, v32, v33
  v_cvt_pk_bf16_f32 v93, v34, v35
  v_cvt_pk_bf16_f32 v94, v36, v37
  v_cvt_pk_bf16_f32 v95, v38, v39
  v_exp_f32 v116, v116
  v_exp_f32 v117, v117
  v_mfma_f32_32x32x16_bf16 v[132:147], v[196:199], v[180:183], v[132:147]
  ds_read_b128 v[196:199], v6 offset:15360
  v_exp_f32 v118, v118
  v_exp_f32 v119, v119
  v_exp_f32 v120, v120
  v_exp_f32 v121, v121
  ds_read_b64_tr_b16 v[204:205], v12 offset:0
  ds_read_b64_tr_b16 v[206:207], v12 offset:1024
  ds_read_b64_tr_b16 v[208:209], v13 offset:0
  ds_read_b64_tr_b16 v[210:211], v13 offset:1024
  v_smfmac_f32_16x16x64_bf16 v[64:67], v[228:231], v[92:99], v1
  v_exp_f32 v122, v122
  v_exp_f32 v123, v123
  v_cvt_pk_bf16_f32 v176, v116, v117
  v_cvt_pk_bf16_f32 v177, v118, v119
  v_cvt_pk_bf16_f32 v178, v120, v121
  v_cvt_pk_bf16_f32 v179, v122, v123
  s_waitcnt lgkmcnt(6)
  v_mfma_f32_32x32x16_bf16 v[16:31], v[188:191], v[88:91], v[16:31]
  v_exp_f32 v40, v40
  v_exp_f32 v41, v41
  v_exp_f32 v42, v42
  v_exp_f32 v43, v43
  v_mfma_f32_32x32x16_bf16 v[100:115], v[188:191], v[172:175], v[100:115]
  ds_read_b128 v[188:191], v7 offset:5120
  v_exp_f32 v44, v44
  v_exp_f32 v45, v45
  v_exp_f32 v46, v46
  v_exp_f32 v47, v47
  v_mfma_f32_32x32x16_bf16 v[48:63], v[192:195], v[92:95], v[48:63]
  buffer_load_dwordx4 v3, s[12:15], s20 offen offset:3072 sc1 lds
  v_cvt_pk_bf16_f32 v96, v40, v41
  v_cvt_pk_bf16_f32 v97, v42, v43
  v_cvt_pk_bf16_f32 v98, v44, v45
  v_cvt_pk_bf16_f32 v99, v46, v47
  v_exp_f32 v124, v124
  v_exp_f32 v125, v125
  v_mfma_f32_32x32x16_bf16 v[132:147], v[192:195], v[176:179], v[132:147]
  ds_read_b128 v[192:195], v7 offset:2048
  v_exp_f32 v126, v126
  v_exp_f32 v127, v127
  v_exp_f32 v128, v128
  v_exp_f32 v129, v129
  s_add_u32 s20, s20, s58
  v_xor_b32 v12, 0x800, v12
  v_xor_b32 v13, 0x800, v13
  v_smfmac_f32_16x16x64_bf16 v[148:151], v[228:231], v[176:183], v1
  v_exp_f32 v130, v130
  v_exp_f32 v131, v131
  s_add_u32 s21, s21, 0x8000
  s_and_b32 s21, s21, 0x1ffff
  s_sub_u32 s23, s23, 1
  s_cmp_lg_u32 s23, 0
  v_mov_b32 v6, v7
  v_add_u32 v7, s21, v4
  v_cvt_pk_bf16_f32 v180, v124, v125
  v_cvt_pk_bf16_f32 v181, v126, v127
  v_cvt_pk_bf16_f32 v182, v128, v129
  v_cvt_pk_bf16_f32 v183, v130, v131
  s_cbranch_scc1 attn_loop
  s_setprio 0
  s_waitcnt lgkmcnt(0)
  v_mfma_f32_32x32x16_bf16 v[48:63], v[196:199], v[96:99], v[48:63]
  v_mfma_f32_16x16x32_bf16 v[32:35], v[200:203], v[96:99], 0
  v_mfma_f32_32x32x16_bf16 v[132:147], v[196:199], v[180:183], v[132:147]
  v_mfma_f32_16x16x32_bf16 v[116:119], v[200:203], v[180:183], 0
  s_add_u32 s24, s44, 131072
  s_xor_b32 s25, s24, 0x4000
  v_add_u32 v8, s24, v2
  v_add_u32 v9, s25, v2
  s_lshl_b32 s24, s8, 8
  s_add_u32 s24, s24, 0x18000
  v_lshl_add_u32 v12, v0, 2, s24
  v_xor_b32 v13, 0x400, v12
  s_lshl_b32 s25, s8, 2
  s_add_u32 s25, s25, 0x18800
  v_mov_b32 v10, s25
  v_and_b32 v11, 7, v0
  v_lshlrev_b32 v11, 2, v11
  v_add_u32 v11, 0x18800, v11
  v_add_f32 v64, v64, v65
  v_add_f32 v64, v64, v32
  v_add_f32 v148, v148, v149
  v_add_f32 v148, v148, v116
  v_max_f32 v14, v64, v148
  v_mov_b32 v15, 0
  v_pk_fma_f32 v[14:15], v[48:49], 0, v[14:15] op_sel_hi:[1,0,1]
  v_pk_fma_f32 v[14:15], v[50:51], 0, v[14:15] op_sel_hi:[1,0,1]
  v_pk_fma_f32 v[14:15], v[52:53], 0, v[14:15] op_sel_hi:[1,0,1]
  v_pk_fma_f32 v[14:15], v[54:55], 0, v[14:15] op_sel_hi:[1,0,1]
  v_pk_fma_f32 v[14:15], v[56:57], 0, v[14:15] op_sel_hi:[1,0,1]
  v_pk_fma_f32 v[14:15], v[58:59], 0, v[14:15] op_sel_hi:[1,0,1]
  v_pk_fma_f32 v[14:15], v[60:61], 0, v[14:15] op_sel_hi:[1,0,1]
  v_pk_fma_f32 v[14:15], v[62:63], 0, v[14:15] op_sel_hi:[1,0,1]
  v_pk_fma_f32 v[14:15], v[132:133], 0, v[14:15] op_sel_hi:[1,0,1]
  v_pk_fma_f32 v[14:15], v[134:135], 0, v[14:15] op_sel_hi:[1,0,1]
  v_pk_fma_f32 v[14:15], v[136:137], 0, v[14:15] op_sel_hi:[1,0,1]
  v_pk_fma_f32 v[14:15], v[138:139], 0, v[14:15] op_sel_hi:[1,0,1]
  v_pk_fma_f32 v[14:15], v[140:141], 0, v[14:15] op_sel_hi:[1,0,1]
  v_pk_fma_f32 v[14:15], v[142:143], 0, v[14:15] op_sel_hi:[1,0,1]
  v_pk_fma_f32 v[14:15], v[144:145], 0, v[14:15] op_sel_hi:[1,0,1]
  v_pk_fma_f32 v[14:15], v[146:147], 0, v[14:15] op_sel_hi:[1,0,1]
  v_add_f32 v14, v14, v15
  v_fma_f32 v14, v64, 0, v14
  v_fma_f32 v14, v148, 0, v14
  v_cmp_ngt_f32 vcc, 0x5d000000, v14
  s_cmp_eq_u32 s11, 0
  s_cbranch_scc1 attn_m0
  v_swap_b32 v48, v132
  v_swap_b32 v49, v133
  v_swap_b32 v50, v134
  v_swap_b32 v51, v135
  v_swap_b32 v52, v136
  v_swap_b32 v53, v137
  v_swap_b32 v54, v138
  v_swap_b32 v55, v139
  v_swap_b32 v56, v140
  v_swap_b32 v57, v141
  v_swap_b32 v58, v142
  v_swap_b32 v59, v143
  v_swap_b32 v60, v144
  v_swap_b32 v61, v145
  v_swap_b32 v62, v146
  v_swap_b32 v63, v147
  v_swap_b32 v64, v148
attn_m0:
  s_cmp_lg_u64 vcc, 0
  s_cselect_b32 s24, 1, 0
  v_mov_b32 v15, s24
  s_waitcnt vmcnt(4)
  ds_write_b128 v8, v[132:135] offset:0
  ds_write_b128 v8, v[136:139] offset:1024
  ds_write_b128 v8, v[140:143] offset:2048
  ds_write_b128 v8, v[144:147] offset:3072
  ds_write_b32 v12, v148
  ds_write_b32 v10, v15
  s_waitcnt lgkmcnt(0)
  s_barrier
  ds_read_b32 v15, v11
  ds_read_b32 v32, v13
  ds_read_b128 v[16:19], v9 offset:0
  ds_read_b128 v[20:23], v9 offset:1024
  ds_read_b128 v[24:27], v9 offset:2048
  ds_read_b128 v[28:31], v9 offset:3072
  s_waitcnt lgkmcnt(0)
  v_cmp_ne_u32 vcc, 0, v15
  v_add_f32 v64, v64, v32
  v_pk_add_f32 v[48:49], v[48:49], v[16:17]
  v_pk_add_f32 v[50:51], v[50:51], v[18:19]
  v_pk_add_f32 v[52:53], v[52:53], v[20:21]
  v_pk_add_f32 v[54:55], v[54:55], v[22:23]
  v_pk_add_f32 v[56:57], v[56:57], v[24:25]
  v_pk_add_f32 v[58:59], v[58:59], v[26:27]
  v_pk_add_f32 v[60:61], v[60:61], v[28:29]
  v_pk_add_f32 v[62:63], v[62:63], v[30:31]
  s_cmp_lg_u32 s40, 0
  s_cbranch_scc1 attn_fin
  s_cmp_eq_u64 vcc, 0
  s_cbranch_scc1 attn_fin
  s_barrier
  s_mov_b32 s40, 2
  s_mov_b32 s43, 0
  s_lshl_b32 s24, s9, 18
  s_add_u32 s24, s24, 0x800000
  s_add_u32 s12, s4, s24
  s_addc_u32 s13, s5, 0
  s_mov_b32 s14, 0x40000
  s_lshl_b32 s25, s11, 17
  s_lshl_b32 s26, s3, 12
  s_add_u32 s25, s25, s26
  v_add_u32 v3, s25, v2
  s_movk_i32 s58, 0x4000
  s_mov_b32 s20, 0
  v_mov_b32 v14, 0xff800000
  v_mov_b32 v15, 0xff800000
attn_mx:
  buffer_load_dwordx4 v[184:187], v2, s[12:15], s20 offen sc1
  buffer_load_dwordx4 v[188:191], v2, s[12:15], s20 offen offset:1024 sc1
  s_add_u32 s20, s20, 0x1000
  s_waitcnt vmcnt(0)
  v_mfma_f32_32x32x16_bf16 v[16:31], v[184:187], v[84:87], 0
  v_mfma_f32_32x32x16_bf16 v[100:115], v[184:187], v[168:171], 0
  v_mfma_f32_32x32x16_bf16 v[16:31], v[188:191], v[88:91], v[16:31]
  v_mfma_f32_32x32x16_bf16 v[100:115], v[188:191], v[172:175], v[100:115]
  s_nop 15
  v_max3_f32 v14, v16, v17, v14
  v_max3_f32 v14, v18, v19, v14
  v_max3_f32 v14, v20, v21, v14
  v_max3_f32 v14, v22, v23, v14
  v_max3_f32 v14, v24, v25, v14
  v_max3_f32 v14, v26, v27, v14
  v_max3_f32 v14, v28, v29, v14
  v_max3_f32 v14, v30, v31, v14
  v_max3_f32 v15, v100, v101, v15
  v_max3_f32 v15, v102, v103, v15
  v_max3_f32 v15, v104, v105, v15
  v_max3_f32 v15, v106, v107, v15
  v_max3_f32 v15, v108, v109, v15
  v_max3_f32 v15, v110, v111, v15
  v_max3_f32 v15, v112, v113, v15
  v_max3_f32 v15, v114, v115, v15
  s_cmp_lt_u32 s20, 0x40000
  s_cbranch_scc1 attn_mx
  v_mov_b32 v8, v14
  v_mov_b32 v9, v15
  s_nop 1
  v_permlane32_swap_b32 v14, v8
  v_permlane32_swap_b32 v15, v9
  s_nop 1
  v_max_f32 v14, v14, v8
  v_max_f32 v15, v15, v9
  s_mov_b32 s20, 0
  s_mov_b32 s22, 0
  s_add_u32 m0, s22, s44
  s_add_u32 s22, s22, 0x8000
  buffer_load_dwordx4 v3, s[12:15], s20 offen offset:0 sc1 lds
  buffer_load_dwordx4 v3, s[12:15], s20 offen offset:1024 sc1 lds
  buffer_load_dwordx4 v3, s[12:15], s20 offen offset:2048 sc1 lds
  buffer_load_dwordx4 v3, s[12:15], s20 offen offset:3072 sc1 lds
  s_add_u32 s20, s20, 0x4000
  s_and_b32 s22, s22, 0x1ffff
  s_add_u32 m0, s22, s44
  s_add_u32 s22, s22, 0x8000
  buffer_load_dwordx4 v3, s[12:15], s20 offen offset:0 sc1 lds
  buffer_load_dwordx4 v3, s[12:15], s20 offen offset:1024 sc1 lds
  buffer_load_dwordx4 v3, s[12:15], s20 offen offset:2048 sc1 lds
  buffer_load_dwordx4 v3, s[12:15], s20 offen offset:3072 sc1 lds
  s_add_u32 s20, s20, 0x4000
  s_and_b32 s22, s22, 0x1ffff
  v_lshrrev_b32 v8, 4, v0
  v_lshrrev_b32 v5, 2, v0
  v_xor_b32 v8, v8, v5
  v_and_b32 v8, 1, v8
  v_cmp_eq_u32 vcc, 0, v8
  v_mov_b32 v5, 0x3f803f80
  s_nop 1
  v_cndmask_b32 v200, 0, v5, vcc
  v_cndmask_b32 v201, 0, v5, vcc
  v_cndmask_b32 v202, 0, v5, vcc
  v_cndmask_b32 v203, 0, v5, vcc
  v_and_b32 v8, 4, v0
  v_cmp_eq_u32 vcc, 0, v8
  s_nop 1
  v_cndmask_b32 v228, 0, v5, vcc
  v_cndmask_b32 v229, 0, v5, vcc
  v_xor_b32 v230, v228, v5
  v_xor_b32 v231, v228, v5
  v_and_b32 v8, 1, v0
  v_cmp_eq_u32 vcc, 0, v8
  v_mov_b32 v1, 0xeeeeeeee
  v_mov_b32 v5, 0x44444444
  v_cndmask_b32 v1, v1, v5, vcc
  v_mov_b32 v48, 0
  v_mov_b32 v49, 0
  v_mov_b32 v50, 0
  v_mov_b32 v51, 0
  v_mov_b32 v52, 0
  v_mov_b32 v53, 0
  v_mov_b32 v54, 0
  v_mov_b32 v55, 0
  v_mov_b32 v56, 0
  v_mov_b32 v57, 0
  v_mov_b32 v58, 0
  v_mov_b32 v59, 0
  v_mov_b32 v60, 0
  v_mov_b32 v61, 0
  v_mov_b32 v62, 0
  v_mov_b32 v63, 0
  v_mov_b32 v64, 0
  v_mov_b32 v65, 0
  v_mov_b32 v66, 0
  v_mov_b32 v67, 0
  v_mov_b32 v96, 0
  v_mov_b32 v97, 0
  v_mov_b32 v98, 0
  v_mov_b32 v99, 0
  v_mov_b32 v132, 0
  v_mov_b32 v133, 0
  v_mov_b32 v134, 0
  v_mov_b32 v135, 0
  v_mov_b32 v136, 0
  v_mov_b32 v137, 0
  v_mov_b32 v138, 0
  v_mov_b32 v139, 0
  v_mov_b32 v140, 0
  v_mov_b32 v141, 0
  v_mov_b32 v142, 0
  v_mov_b32 v143, 0
  v_mov_b32 v144, 0
  v_mov_b32 v145, 0
  v_mov_b32 v146, 0
  v_mov_b32 v147, 0
  v_mov_b32 v148, 0
  v_mov_b32 v149, 0
  v_mov_b32 v150, 0
  v_mov_b32 v151, 0
  v_mov_b32 v180, 0
  v_mov_b32 v181, 0
  v_mov_b32 v182, 0
  v_mov_b32 v183, 0
  v_mov_b32 v196, 0
  v_mov_b32 v197, 0
  v_mov_b32 v198, 0
  v_mov_b32 v199, 0
  v_mov_b32 v6, v4
  v_add_u32 v7, 0x8000, v4
  s_mov_b32 s23, 8
  s_mov_b32 s21, 0x8000
  s_nop 0
  s_mov_b32 s50, 0x7f000000
  s_mov_b32 s53, s50
  s_branch attn_restart
attn_wf:
  s_lshl_b32 s24, s2, 2
  s_add_u32 s24, s24, 131072
  v_mov_b32 v8, 0
  v_mov_b32 v9, 1
  s_mov_b64 exec, 1
  buffer_store_dword v9, v8, s[36:39], s24 offen sc1
  s_mov_b64 exec, -1
  s_branch attn_wfr
attn_cs:
  s_add_u32 s48, s4, 42991616
  s_addc_u32 s49, s5, 0
  s_mul_i32 s24, s60, 14336
  s_lshl_b32 s25, s61, 7
  s_add_u32 s24, s24, s25
  v_and_b32 v8, 1, v0
  v_cmp_eq_u32 vcc, 1, v8
  v_lshlrev_b32 v8, 6, v8
  v_lshrrev_b32 v9, 4, v0
  v_lshl_add_u32 v8, v9, 4, v8
  v_add_u32 v8, s24, v8
  v_cndmask_b32 v224, v212, v216, vcc
  v_cndmask_b32 v225, v213, v217, vcc
  v_cndmask_b32 v226, v214, v218, vcc
  v_cndmask_b32 v227, v215, v219, vcc
  s_mov_b32 exec_lo, 0x30003
  s_mov_b32 exec_hi, 0x30003
  global_store_dwordx4 v8, v[224:227], s[48:49] sc1
  s_mov_b64 exec, -1
  s_branch attn_csr
attn_sw:
  s_getpc_b64 s[12:13]
pc7:
  s_add_u32 s12, s12, main_go-pc7
  s_addc_u32 s13, s13, (main_go-pc7)>>32
  s_lshr_b32 s14, s2, 3
  s_lshl_b32 s14, s14, 11
  v_lshl_add_u32 v8, v0, 4, s14
  s_mov_b32 s14, main_end-main_go
  s_mov_b32 s15, 0x20000
  buffer_load_dwordx4 v[252:255], v8, s[12:15], 0 offen sc1
  buffer_load_dwordx4 v[252:255], v8, s[12:15], 0 offen offset:1024 sc1
  s_bfe_u32 s24, s2, 0x10002
  s_lshl_b32 s24, s24, 3
  s_lshr_b32 s25, s2, 5
  s_add_u32 s24, s24, s25
  s_and_b32 s25, s2, 3
  s_lshl_b32 s25, s25, 2
  s_bfe_u32 s26, s2, 0x20003
  s_add_u32 s25, s25, s26
  s_lshl_b32 s25, s25, 3
  s_add_u32 s25, s25, s8
  s_lshl_b32 s25, s25, 15
  s_lshl_b32 s26, s24, 7
  s_add_u32 s25, s25, s26
  s_mov_b32 s12, s88
  s_mov_b32 s13, s89
  s_mov_b32 s14, 4194304
  v_and_b32 v8, 15, v0
  v_lshlrev_b32 v8, 11, v8
  v_lshrrev_b32 v9, 4, v0
  v_lshl_add_u32 v8, v9, 3, v8
  buffer_load_dwordx2 v[232:233], v8, s[12:15], s25 offen sc1
  buffer_load_dwordx2 v[234:235], v8, s[12:15], s25 offen offset:32 sc1
  buffer_load_dwordx2 v[236:237], v8, s[12:15], s25 offen offset:64 sc1
  buffer_load_dwordx2 v[238:239], v8, s[12:15], s25 offen offset:96 sc1
  s_lshl_b32 s24, s24, 17
  s_add_u32 s24, s24, 0x3600000
  s_add_u32 s12, s4, s24
  s_addc_u32 s13, s5, 0
  s_mov_b32 s14, 0x20000
  s_mov_b32 s20, 0
  s_mov_b32 s58, 0x8000
  v_add_u32 v3, s44, v2
  s_branch attn_swr
attn_fin:
  v_rcp_f32 v8, v64
  s_lshl_b32 s24, s10, 1
  s_add_u32 s24, s24, s11
  s_lshl_b32 s24, s24, 16
  s_lshl_b32 s25, s9, 10
  s_add_u32 s24, s24, s25
  v_bfe_u32 v9, v0, 4, 1
  v_lshlrev_b32 v9, 15, v9
  v_and_b32 v10, 15, v0
  v_lshl_add_u32 v9, v10, 4, v9
  v_lshrrev_b32 v10, 5, v0
  v_lshl_add_u32 v9, v10, 8, v9
  v_pk_mul_f32 v[48:49], v[48:49], v[8:9] op_sel_hi:[1,0]
  v_pk_mul_f32 v[50:51], v[50:51], v[8:9] op_sel_hi:[1,0]
  v_pk_mul_f32 v[52:53], v[52:53], v[8:9] op_sel_hi:[1,0]
  v_pk_mul_f32 v[54:55], v[54:55], v[8:9] op_sel_hi:[1,0]
  v_pk_mul_f32 v[56:57], v[56:57], v[8:9] op_sel_hi:[1,0]
  v_pk_mul_f32 v[58:59], v[58:59], v[8:9] op_sel_hi:[1,0]
  v_pk_mul_f32 v[60:61], v[60:61], v[8:9] op_sel_hi:[1,0]
  v_pk_mul_f32 v[62:63], v[62:63], v[8:9] op_sel_hi:[1,0]
  v_cvt_pk_bf16_f32 v92, v48, v49
  v_cvt_pk_bf16_f32 v93, v50, v51
  v_cvt_pk_bf16_f32 v94, v52, v53
  v_cvt_pk_bf16_f32 v95, v54, v55
  v_cvt_pk_bf16_f32 v96, v56, v57
  v_cvt_pk_bf16_f32 v97, v58, v59
  v_cvt_pk_bf16_f32 v98, v60, v61
  v_cvt_pk_bf16_f32 v99, v62, v63
  buffer_store_dwordx4 v[92:95], v9, s[16:19], s24 offen sc1
  buffer_store_dwordx4 v[96:99], v9, s[16:19], s24 offen offset:512 sc1
  s_nop 0
  s_mov_b64 exec, -1
  s_lshr_b32 s24, s10, 2
  s_lshl_b32 s24, s24, 12
  s_lshl_b32 s25, s9, 7
  s_add_u32 s24, s24, s25
  s_add_u32 s42, s24, 32768
wo:
  s_and_b32 s24, s2, 7
  s_mov_b32 s8, s62
  s_lshr_b32 s25, s2, 3
  s_and_b32 s26, s24, 3
  s_lshl_b32 s26, s26, 2
  s_and_b32 s9, s25, 3
  s_add_u32 s9, s9, s26
  s_lshr_b32 s26, s24, 2
  s_lshl_b32 s26, s26, 3
  s_lshr_b32 s10, s25, 2
  s_add_u32 s10, s10, s26
  s_lshl_b32 s27, s9, 3
  s_add_u32 s27, s27, s8
  v_and_b32 v1, 15, v0
  v_lshrrev_b32 v2, 4, v0
  v_lshlrev_b32 v3, 4, v0
  v_add_u32 v4, 0x10000, v3
  s_lshl_b32 s20, s27, 15
  s_lshl_b32 s44, s8, 12
  s_add_u32 s44, s44, 0x18000
  s_lshl_b32 s21, s10, 17
  s_add_u32 s21, s21, s44
  s_add_u32 s12, s4, 0x1000000
  s_addc_u32 s13, s5, 0
  s_mov_b32 s14, 0x400000
  s_mov_b32 s15, 0x20000
  s_add_u32 s16, s4, 0x3600000
  s_addc_u32 s17, s5, 0
  s_mov_b32 s18, 0x200000
  s_mov_b32 s19, 0x20000
  v_mov_b32 v16, 0
  v_mov_b32 v17, 0
  v_mov_b32 v18, 0
  v_mov_b32 v19, 0
  v_mov_b32 v20, 0
  v_mov_b32 v21, 0
  v_mov_b32 v22, 0
  v_mov_b32 v23, 0
  v_mov_b32 v24, 0
  v_mov_b32 v25, 0
  v_mov_b32 v26, 0
  v_mov_b32 v27, 0
  v_mov_b32 v28, 0
  v_mov_b32 v29, 0
  v_mov_b32 v30, 0
  v_mov_b32 v31, 0
  s_waitcnt vmcnt(0)
  s_lshr_b32 s24, s9, 1
  s_lshl_b32 s24, s24, 12
  s_add_u32 s24, s24, 32768
  s_add_u32 s36, s4, 0x2a00000
  s_addc_u32 s37, s5, 0
  s_mov_b32 s38, 0x40000
  s_mov_b32 s39, 0x20000
  s_barrier
  s_cmp_eq_u32 s62, 4
  s_cbranch_scc0 ho8a
  v_mov_b32 v10, 0
  v_mov_b32 v11, 1
  s_mov_b64 exec, 1
  buffer_store_dword v11, v10, s[36:39], s42 offen sc1
  s_mov_b64 exec, -1
ho8a:
  s_cmp_eq_u32 s62, 7
  s_cbranch_scc0 ho8
  v_and_b32 v8, 31, v0
  v_lshlrev_b32 v8, 7, v8
  s_mov_b32 s63, 0x40000
poll9:
  buffer_load_dword v12, v8, s[36:39], s24 offen sc1
  s_sub_u32 s63, s63, 1
  s_waitcnt vmcnt(0)
  v_cmp_eq_u32 vcc, 0, v12
  s_nop 3
  s_cbranch_scc1 poll9x
  s_cbranch_vccz poll9x
  s_sleep 2
  s_branch poll9
poll9x:
  s_barrier
  s_mov_b32 m0, s44
  s_mov_b32 s25, 131072
  buffer_load_dwordx4 v3, s[16:19], s21 offen offset:0 sc1 lds
  buffer_load_dwordx4 v3, s[16:19], s21 offen offset:1024 sc1 lds
  buffer_load_dwordx4 v3, s[16:19], s21 offen offset:2048 sc1 lds
  buffer_load_dwordx4 v3, s[16:19], s21 offen offset:3072 sc1 lds
  s_branch ho8b
ho8:
  s_mov_b32 m0, s44
  s_mov_b32 s25, 131072
  buffer_load_dwordx4 v3, s[16:19], s21 offen offset:0 sc1 lds
  buffer_load_dwordx4 v3, s[16:19], s21 offen offset:1024 sc1 lds
  buffer_load_dwordx4 v3, s[16:19], s21 offen offset:2048 sc1 lds
  buffer_load_dwordx4 v3, s[16:19], s21 offen offset:3072 sc1 lds
  s_barrier
ho8b:
  buffer_load_dwordx4 v[72:75], v3, s[12:15], s20 offen offset:0 sc1
  buffer_load_dwordx4 v[76:79], v3, s[12:15], s20 offen offset:1024 sc1
  buffer_load_dwordx4 v[80:83], v3, s[12:15], s20 offen offset:2048 sc1
  buffer_load_dwordx4 v[84:87], v3, s[12:15], s20 offen offset:3072 sc1
  s_add_u32 s20, s20, 4096
  buffer_load_dwordx4 v[88:91], v3, s[12:15], s20 offen offset:0 sc1
  buffer_load_dwordx4 v[92:95], v3, s[12:15], s20 offen offset:1024 sc1
  buffer_load_dwordx4 v[96:99], v3, s[12:15], s20 offen offset:2048 sc1
  buffer_load_dwordx4 v[100:103], v3, s[12:15], s20 offen offset:3072 sc1
  s_add_u32 s20, s20, 4096
  ds_read_b128 v[32:35], v3 offset:0
  ds_read_b128 v[36:39], v3 offset:1024
  ds_read_b128 v[40:43], v3 offset:2048
  ds_read_b128 v[44:47], v3 offset:3072
  s_waitcnt vmcnt(7) lgkmcnt(0)
  v_mfma_f32_16x16x32_bf16 v[16:19], v[32:35], v[72:75], v[16:19]
  ds_read_b128 v[48:51], v3 offset:4096
  ds_read_b128 v[52:55], v3 offset:5120
  v_mfma_f32_16x16x32_bf16 v[20:23], v[36:39], v[72:75], v[20:23]
  ds_read_b128 v[56:59], v3 offset:6144
  ds_read_b128 v[60:63], v3 offset:7168
  v_mfma_f32_16x16x32_bf16 v[24:27], v[40:43], v[72:75], v[24:27]
  v_mfma_f32_16x16x32_bf16 v[28:31], v[44:47], v[72:75], v[28:31]
  buffer_load_dwordx4 v[104:107], v3, s[12:15], s20 offen offset:0 sc1
  s_waitcnt vmcnt(7) lgkmcnt(0)
  v_mfma_f32_16x16x32_bf16 v[16:19], v[48:51], v[76:79], v[16:19]
  ds_read_b128 v[32:35], v3 offset:8192
  ds_read_b128 v[36:39], v3 offset:9216
  v_mfma_f32_16x16x32_bf16 v[20:23], v[52:55], v[76:79], v[20:23]
  ds_read_b128 v[40:43], v3 offset:10240
  ds_read_b128 v[44:47], v3 offset:11264
  v_mfma_f32_16x16x32_bf16 v[24:27], v[56:59], v[76:79], v[24:27]
  v_mfma_f32_16x16x32_bf16 v[28:31], v[60:63], v[76:79], v[28:31]
  buffer_load_dwordx4 v[72:75], v3, s[12:15], s20 offen offset:1024 sc1
  s_waitcnt vmcnt(7) lgkmcnt(0)
  v_mfma_f32_16x16x32_bf16 v[16:19], v[32:35], v[80:83], v[16:19]
  ds_read_b128 v[48:51], v3 offset:12288
  ds_read_b128 v[52:55], v3 offset:13312
  v_mfma_f32_16x16x32_bf16 v[20:23], v[36:39], v[80:83], v[20:23]
  ds_read_b128 v[56:59], v3 offset:14336
  ds_read_b128 v[60:63], v3 offset:15360
  v_mfma_f32_16x16x32_bf16 v[24:27], v[40:43], v[80:83], v[24:27]
  v_mfma_f32_16x16x32_bf16 v[28:31], v[44:47], v[80:83], v[28:31]
  buffer_load_dwordx4 v[76:79], v3, s[12:15], s20 offen offset:2048 sc1
  s_waitcnt vmcnt(7) lgkmcnt(0)
  v_mfma_f32_16x16x32_bf16 v[16:19], v[48:51], v[84:87], v[16:19]
  ds_read_b128 v[32:35], v3 offset:16384
  ds_read_b128 v[36:39], v3 offset:17408
  v_mfma_f32_16x16x32_bf16 v[20:23], v[52:55], v[84:87], v[20:23]
  ds_read_b128 v[40:43], v3 offset:18432
  ds_read_b128 v[44:47], v3 offset:19456
  v_mfma_f32_16x16x32_bf16 v[24:27], v[56:59], v[84:87], v[24:27]
  v_mfma_f32_16x16x32_bf16 v[28:31], v[60:63], v[84:87], v[28:31]
  buffer_load_dwordx4 v[80:83], v3, s[12:15], s20 offen offset:3072 sc1
  s_add_u32 s20, s20, 4096
  s_waitcnt vmcnt(7) lgkmcnt(0)
  v_mfma_f32_16x16x32_bf16 v[16:19], v[32:35], v[88:91], v[16:19]
  ds_read_b128 v[48:51], v3 offset:20480
  ds_read_b128 v[52:55], v3 offset:21504
  v_mfma_f32_16x16x32_bf16 v[20:23], v[36:39], v[88:91], v[20:23]
  ds_read_b128 v[56:59], v3 offset:22528
  ds_read_b128 v[60:63], v3 offset:23552
  v_mfma_f32_16x16x32_bf16 v[24:27], v[40:43], v[88:91], v[24:27]
  v_mfma_f32_16x16x32_bf16 v[28:31], v[44:47], v[88:91], v[28:31]
  buffer_load_dwordx4 v[84:87], v3, s[12:15], s20 offen offset:0 sc1
  s_waitcnt vmcnt(7) lgkmcnt(0)
  v_mfma_f32_16x16x32_bf16 v[16:19], v[48:51], v[92:95], v[16:19]
  ds_read_b128 v[32:35], v3 offset:24576
  ds_read_b128 v[36:39], v3 offset:25600
  v_mfma_f32_16x16x32_bf16 v[20:23], v[52:55], v[92:95], v[20:23]
  ds_read_b128 v[40:43], v3 offset:26624
  ds_read_b128 v[44:47], v3 offset:27648
  v_mfma_f32_16x16x32_bf16 v[24:27], v[56:59], v[92:95], v[24:27]
  v_mfma_f32_16x16x32_bf16 v[28:31], v[60:63], v[92:95], v[28:31]
  buffer_load_dwordx4 v[88:91], v3, s[12:15], s20 offen offset:1024 sc1
  s_waitcnt vmcnt(7) lgkmcnt(0)
  v_mfma_f32_16x16x32_bf16 v[16:19], v[32:35], v[96:99], v[16:19]
  ds_read_b128 v[48:51], v3 offset:28672
  ds_read_b128 v[52:55], v3 offset:29696
  v_mfma_f32_16x16x32_bf16 v[20:23], v[36:39], v[96:99], v[20:23]
  ds_read_b128 v[56:59], v3 offset:30720
  ds_read_b128 v[60:63], v3 offset:31744
  v_mfma_f32_16x16x32_bf16 v[24:27], v[40:43], v[96:99], v[24:27]
  v_mfma_f32_16x16x32_bf16 v[28:31], v[44:47], v[96:99], v[28:31]
  buffer_load_dwordx4 v[92:95], v3, s[12:15], s20 offen offset:2048 sc1
  s_waitcnt vmcnt(7) lgkmcnt(0)
  v_mfma_f32_16x16x32_bf16 v[16:19], v[48:51], v[100:103], v[16:19]
  ds_read_b128 v[32:35], v3 offset:32768
  ds_read_b128 v[36:39], v3 offset:33792
  v_mfma_f32_16x16x32_bf16 v[20:23], v[52:55], v[100:103], v[20:23]
  ds_read_b128 v[40:43], v3 offset:34816
  ds_read_b128 v[44:47], v3 offset:35840
  v_mfma_f32_16x16x32_bf16 v[24:27], v[56:59], v[100:103], v[24:27]
  v_mfma_f32_16x16x32_bf16 v[28:31], v[60:63], v[100:103], v[28:31]
  buffer_load_dwordx4 v[96:99], v3, s[12:15], s20 offen offset:3072 sc1
  s_add_u32 s20, s20, 4096
  s_waitcnt vmcnt(7) lgkmcnt(0)
  v_mfma_f32_16x16x32_bf16 v[16:19], v[32:35], v[104:107], v[16:19]
  ds_read_b128 v[48:51], v3 offset:36864
  ds_read_b128 v[52:55], v3 offset:37888
  v_mfma_f32_16x16x32_bf16 v[20:23], v[36:39], v[104:107], v[20:23]
  ds_read_b128 v[56:59], v3 offset:38912
  ds_read_b128 v[60:63], v3 offset:39936
  v_mfma_f32_16x16x32_bf16 v[24:27], v[40:43], v[104:107], v[24:27]
  v_mfma_f32_16x16x32_bf16 v[28:31], v[44:47], v[104:107], v[28:31]
  buffer_load_dwordx4 v[100:103], v3, s[12:15], s20 offen offset:0 sc1
  s_waitcnt vmcnt(7) lgkmcnt(0)
  v_mfma_f32_16x16x32_bf16 v[16:19], v[48:51], v[72:75], v[16:19]
  ds_read_b128 v[32:35], v3 offset:40960
  ds_read_b128 v[36:39], v3 offset:41984
  v_mfma_f32_16x16x32_bf16 v[20:23], v[52:55], v[72:75], v[20:23]
  ds_read_b128 v[40:43], v3 offset:43008
  ds_read_b128 v[44:47], v3 offset:44032
  v_mfma_f32_16x16x32_bf16 v[24:27], v[56:59], v[72:75], v[24:27]
  v_mfma_f32_16x16x32_bf16 v[28:31], v[60:63], v[72:75], v[28:31]
  buffer_load_dwordx4 v[104:107], v3, s[12:15], s20 offen offset:1024 sc1
  s_waitcnt vmcnt(7) lgkmcnt(0)
  v_mfma_f32_16x16x32_bf16 v[16:19], v[32:35], v[76:79], v[16:19]
  ds_read_b128 v[48:51], v3 offset:45056
  ds_read_b128 v[52:55], v3 offset:46080
  v_mfma_f32_16x16x32_bf16 v[20:23], v[36:39], v[76:79], v[20:23]
  ds_read_b128 v[56:59], v3 offset:47104
  ds_read_b128 v[60:63], v3 offset:48128
  v_mfma_f32_16x16x32_bf16 v[24:27], v[40:43], v[76:79], v[24:27]
  v_mfma_f32_16x16x32_bf16 v[28:31], v[44:47], v[76:79], v[28:31]
  buffer_load_dwordx4 v[72:75], v3, s[12:15], s20 offen offset:2048 sc1
  s_waitcnt vmcnt(7) lgkmcnt(0)
  v_mfma_f32_16x16x32_bf16 v[16:19], v[48:51], v[80:83], v[16:19]
  ds_read_b128 v[32:35], v3 offset:49152
  ds_read_b128 v[36:39], v3 offset:50176
  v_mfma_f32_16x16x32_bf16 v[20:23], v[52:55], v[80:83], v[20:23]
  ds_read_b128 v[40:43], v3 offset:51200
  ds_read_b128 v[44:47], v3 offset:52224
  v_mfma_f32_16x16x32_bf16 v[24:27], v[56:59], v[80:83], v[24:27]
  v_mfma_f32_16x16x32_bf16 v[28:31], v[60:63], v[80:83], v[28:31]
  buffer_load_dwordx4 v[76:79], v3, s[12:15], s20 offen offset:3072 sc1
  s_add_u32 s20, s20, 4096
  s_barrier
  s_waitcnt vmcnt(7) lgkmcnt(0)
  v_mfma_f32_16x16x32_bf16 v[16:19], v[32:35], v[84:87], v[16:19]
  ds_read_b128 v[48:51], v3 offset:53248
  ds_read_b128 v[52:55], v3 offset:54272
  v_mfma_f32_16x16x32_bf16 v[20:23], v[36:39], v[84:87], v[20:23]
  ds_read_b128 v[56:59], v3 offset:55296
  ds_read_b128 v[60:63], v3 offset:56320
  v_mfma_f32_16x16x32_bf16 v[24:27], v[40:43], v[84:87], v[24:27]
  v_mfma_f32_16x16x32_bf16 v[28:31], v[44:47], v[84:87], v[28:31]
  buffer_load_dwordx4 v[80:83], v3, s[12:15], s20 offen offset:0 sc1
  s_waitcnt vmcnt(7) lgkmcnt(0)
  v_mfma_f32_16x16x32_bf16 v[16:19], v[48:51], v[88:91], v[16:19]
  ds_read_b128 v[32:35], v3 offset:57344
  ds_read_b128 v[36:39], v3 offset:58368
  v_mfma_f32_16x16x32_bf16 v[20:23], v[52:55], v[88:91], v[20:23]
  ds_read_b128 v[40:43], v3 offset:59392
  ds_read_b128 v[44:47], v3 offset:60416
  v_mfma_f32_16x16x32_bf16 v[24:27], v[56:59], v[88:91], v[24:27]
  v_mfma_f32_16x16x32_bf16 v[28:31], v[60:63], v[88:91], v[28:31]
  buffer_load_dwordx4 v[84:87], v3, s[12:15], s20 offen offset:1024 sc1
  s_waitcnt vmcnt(7) lgkmcnt(0)
  v_mfma_f32_16x16x32_bf16 v[16:19], v[32:35], v[92:95], v[16:19]
  ds_read_b128 v[48:51], v3 offset:61440
  ds_read_b128 v[52:55], v3 offset:62464
  v_mfma_f32_16x16x32_bf16 v[20:23], v[36:39], v[92:95], v[20:23]
  ds_read_b128 v[56:59], v3 offset:63488
  ds_read_b128 v[60:63], v3 offset:64512
  v_mfma_f32_16x16x32_bf16 v[24:27], v[40:43], v[92:95], v[24:27]
  v_mfma_f32_16x16x32_bf16 v[28:31], v[44:47], v[92:95], v[28:31]
  buffer_load_dwordx4 v[88:91], v3, s[12:15], s20 offen offset:2048 sc1
  s_waitcnt vmcnt(7) lgkmcnt(0)
  v_mfma_f32_16x16x32_bf16 v[16:19], v[48:51], v[96:99], v[16:19]
  ds_read_b128 v[32:35], v4 offset:0
  ds_read_b128 v[36:39], v4 offset:1024
  v_mfma_f32_16x16x32_bf16 v[20:23], v[52:55], v[96:99], v[20:23]
  ds_read_b128 v[40:43], v4 offset:2048
  ds_read_b128 v[44:47], v4 offset:3072
  v_mfma_f32_16x16x32_bf16 v[24:27], v[56:59], v[96:99], v[24:27]
  v_mfma_f32_16x16x32_bf16 v[28:31], v[60:63], v[96:99], v[28:31]
  buffer_load_dwordx4 v[92:95], v3, s[12:15], s20 offen offset:3072 sc1
  s_add_u32 s20, s20, 4096
  s_waitcnt vmcnt(7) lgkmcnt(0)
  v_mfma_f32_16x16x32_bf16 v[16:19], v[32:35], v[100:103], v[16:19]
  ds_read_b128 v[48:51], v4 offset:4096
  ds_read_b128 v[52:55], v4 offset:5120
  v_mfma_f32_16x16x32_bf16 v[20:23], v[36:39], v[100:103], v[20:23]
  ds_read_b128 v[56:59], v4 offset:6144
  ds_read_b128 v[60:63], v4 offset:7168
  v_mfma_f32_16x16x32_bf16 v[24:27], v[40:43], v[100:103], v[24:27]
  v_mfma_f32_16x16x32_bf16 v[28:31], v[44:47], v[100:103], v[28:31]
  buffer_load_dwordx4 v[96:99], v3, s[12:15], s20 offen offset:0 sc1
  s_waitcnt vmcnt(7) lgkmcnt(0)
  v_mfma_f32_16x16x32_bf16 v[16:19], v[48:51], v[104:107], v[16:19]
  ds_read_b128 v[32:35], v4 offset:8192
  ds_read_b128 v[36:39], v4 offset:9216
  v_mfma_f32_16x16x32_bf16 v[20:23], v[52:55], v[104:107], v[20:23]
  ds_read_b128 v[40:43], v4 offset:10240
  ds_read_b128 v[44:47], v4 offset:11264
  v_mfma_f32_16x16x32_bf16 v[24:27], v[56:59], v[104:107], v[24:27]
  v_mfma_f32_16x16x32_bf16 v[28:31], v[60:63], v[104:107], v[28:31]
  buffer_load_dwordx4 v[100:103], v3, s[12:15], s20 offen offset:1024 sc1
  s_waitcnt vmcnt(7) lgkmcnt(0)
  v_mfma_f32_16x16x32_bf16 v[16:19], v[32:35], v[72:75], v[16:19]
  ds_read_b128 v[48:51], v4 offset:12288
  ds_read_b128 v[52:55], v4 offset:13312
  v_mfma_f32_16x16x32_bf16 v[20:23], v[36:39], v[72:75], v[20:23]
  ds_read_b128 v[56:59], v4 offset:14336
  ds_read_b128 v[60:63], v4 offset:15360
  v_mfma_f32_16x16x32_bf16 v[24:27], v[40:43], v[72:75], v[24:27]
  v_mfma_f32_16x16x32_bf16 v[28:31], v[44:47], v[72:75], v[28:31]
  buffer_load_dwordx4 v[104:107], v3, s[12:15], s20 offen offset:2048 sc1
  s_waitcnt vmcnt(7) lgkmcnt(0)
  v_mfma_f32_16x16x32_bf16 v[16:19], v[48:51], v[76:79], v[16:19]
  ds_read_b128 v[32:35], v4 offset:16384
  ds_read_b128 v[36:39], v4 offset:17408
  v_mfma_f32_16x16x32_bf16 v[20:23], v[52:55], v[76:79], v[20:23]
  ds_read_b128 v[40:43], v4 offset:18432
  ds_read_b128 v[44:47], v4 offset:19456
  v_mfma_f32_16x16x32_bf16 v[24:27], v[56:59], v[76:79], v[24:27]
  v_mfma_f32_16x16x32_bf16 v[28:31], v[60:63], v[76:79], v[28:31]
  buffer_load_dwordx4 v[72:75], v3, s[12:15], s20 offen offset:3072 sc1
  s_add_u32 s20, s20, 4096
  s_waitcnt vmcnt(7) lgkmcnt(0)
  v_mfma_f32_16x16x32_bf16 v[16:19], v[32:35], v[80:83], v[16:19]
  ds_read_b128 v[48:51], v4 offset:20480
  ds_read_b128 v[52:55], v4 offset:21504
  v_mfma_f32_16x16x32_bf16 v[20:23], v[36:39], v[80:83], v[20:23]
  ds_read_b128 v[56:59], v4 offset:22528
  ds_read_b128 v[60:63], v4 offset:23552
  v_mfma_f32_16x16x32_bf16 v[24:27], v[40:43], v[80:83], v[24:27]
  v_mfma_f32_16x16x32_bf16 v[28:31], v[44:47], v[80:83], v[28:31]
  buffer_load_dwordx4 v[76:79], v3, s[12:15], s20 offen offset:0 sc1
  s_waitcnt vmcnt(7) lgkmcnt(0)
  v_mfma_f32_16x16x32_bf16 v[16:19], v[48:51], v[84:87], v[16:19]
  ds_read_b128 v[32:35], v4 offset:24576
  ds_read_b128 v[36:39], v4 offset:25600
  v_mfma_f32_16x16x32_bf16 v[20:23], v[52:55], v[84:87], v[20:23]
  ds_read_b128 v[40:43], v4 offset:26624
  ds_read_b128 v[44:47], v4 offset:27648
  v_mfma_f32_16x16x32_bf16 v[24:27], v[56:59], v[84:87], v[24:27]
  v_mfma_f32_16x16x32_bf16 v[28:31], v[60:63], v[84:87], v[28:31]
  buffer_load_dwordx4 v[80:83], v3, s[12:15], s20 offen offset:1024 sc1
  s_waitcnt vmcnt(7) lgkmcnt(0)
  v_mfma_f32_16x16x32_bf16 v[16:19], v[32:35], v[88:91], v[16:19]
  ds_read_b128 v[48:51], v4 offset:28672
  ds_read_b128 v[52:55], v4 offset:29696
  v_mfma_f32_16x16x32_bf16 v[20:23], v[36:39], v[88:91], v[20:23]
  ds_read_b128 v[56:59], v4 offset:30720
  ds_read_b128 v[60:63], v4 offset:31744
  v_mfma_f32_16x16x32_bf16 v[24:27], v[40:43], v[88:91], v[24:27]
  v_mfma_f32_16x16x32_bf16 v[28:31], v[44:47], v[88:91], v[28:31]
  buffer_load_dwordx4 v[84:87], v3, s[12:15], s20 offen offset:2048 sc1
  s_waitcnt vmcnt(7) lgkmcnt(0)
  v_mfma_f32_16x16x32_bf16 v[16:19], v[48:51], v[92:95], v[16:19]
  ds_read_b128 v[32:35], v4 offset:32768
  ds_read_b128 v[36:39], v4 offset:33792
  v_mfma_f32_16x16x32_bf16 v[20:23], v[52:55], v[92:95], v[20:23]
  ds_read_b128 v[40:43], v4 offset:34816
  ds_read_b128 v[44:47], v4 offset:35840
  v_mfma_f32_16x16x32_bf16 v[24:27], v[56:59], v[92:95], v[24:27]
  v_mfma_f32_16x16x32_bf16 v[28:31], v[60:63], v[92:95], v[28:31]
  buffer_load_dwordx4 v[88:91], v3, s[12:15], s20 offen offset:3072 sc1
  s_add_u32 s20, s20, 4096
  s_waitcnt vmcnt(7) lgkmcnt(0)
  v_mfma_f32_16x16x32_bf16 v[16:19], v[32:35], v[96:99], v[16:19]
  ds_read_b128 v[48:51], v4 offset:36864
  ds_read_b128 v[52:55], v4 offset:37888
  v_mfma_f32_16x16x32_bf16 v[20:23], v[36:39], v[96:99], v[20:23]
  ds_read_b128 v[56:59], v4 offset:38912
  ds_read_b128 v[60:63], v4 offset:39936
  v_mfma_f32_16x16x32_bf16 v[24:27], v[40:43], v[96:99], v[24:27]
  v_mfma_f32_16x16x32_bf16 v[28:31], v[44:47], v[96:99], v[28:31]
  v_mov_b32 v240, v3
  buffer_load_dwordx4 v[244:247], v3, s[36:39], s25 offen sc1
  s_waitcnt vmcnt(7) lgkmcnt(0)
  v_mfma_f32_16x16x32_bf16 v[16:19], v[48:51], v[100:103], v[16:19]
  ds_read_b128 v[32:35], v4 offset:40960
  ds_read_b128 v[36:39], v4 offset:41984
  v_mfma_f32_16x16x32_bf16 v[20:23], v[52:55], v[100:103], v[20:23]
  ds_read_b128 v[40:43], v4 offset:43008
  ds_read_b128 v[44:47], v4 offset:44032
  v_mfma_f32_16x16x32_bf16 v[24:27], v[56:59], v[100:103], v[24:27]
  v_mfma_f32_16x16x32_bf16 v[28:31], v[60:63], v[100:103], v[28:31]
  s_waitcnt vmcnt(6) lgkmcnt(0)
  v_mfma_f32_16x16x32_bf16 v[16:19], v[32:35], v[104:107], v[16:19]
  ds_read_b128 v[48:51], v4 offset:45056
  ds_read_b128 v[52:55], v4 offset:46080
  v_mfma_f32_16x16x32_bf16 v[20:23], v[36:39], v[104:107], v[20:23]
  ds_read_b128 v[56:59], v4 offset:47104
  ds_read_b128 v[60:63], v4 offset:48128
  v_mfma_f32_16x16x32_bf16 v[24:27], v[40:43], v[104:107], v[24:27]
  v_mfma_f32_16x16x32_bf16 v[28:31], v[44:47], v[104:107], v[28:31]
  s_waitcnt vmcnt(5) lgkmcnt(0)
  v_mfma_f32_16x16x32_bf16 v[16:19], v[48:51], v[72:75], v[16:19]
  ds_read_b128 v[32:35], v4 offset:49152
  ds_read_b128 v[36:39], v4 offset:50176
  v_mfma_f32_16x16x32_bf16 v[20:23], v[52:55], v[72:75], v[20:23]
  ds_read_b128 v[40:43], v4 offset:51200
  ds_read_b128 v[44:47], v4 offset:52224
  v_mfma_f32_16x16x32_bf16 v[24:27], v[56:59], v[72:75], v[24:27]
  v_mfma_f32_16x16x32_bf16 v[28:31], v[60:63], v[72:75], v[28:31]
  s_waitcnt vmcnt(4) lgkmcnt(0)
  v_mfma_f32_16x16x32_bf16 v[16:19], v[32:35], v[76:79], v[16:19]
  ds_read_b128 v[48:51], v4 offset:53248
  ds_read_b128 v[52:55], v4 offset:54272
  v_mfma_f32_16x16x32_bf16 v[20:23], v[36:39], v[76:79], v[20:23]
  ds_read_b128 v[56:59], v4 offset:55296
  ds_read_b128 v[60:63], v4 offset:56320
  v_mfma_f32_16x16x32_bf16 v[24:27], v[40:43], v[76:79], v[24:27]
  v_mfma_f32_16x16x32_bf16 v[28:31], v[44:47], v[76:79], v[28:31]
  s_waitcnt vmcnt(3) lgkmcnt(0)
  v_mfma_f32_16x16x32_bf16 v[16:19], v[48:51], v[80:83], v[16:19]
  ds_read_b128 v[32:35], v4 offset:57344
  ds_read_b128 v[36:39], v4 offset:58368
  v_mfma_f32_16x16x32_bf16 v[20:23], v[52:55], v[80:83], v[20:23]
  ds_read_b128 v[40:43], v4 offset:59392
  ds_read_b128 v[44:47], v4 offset:60416
  v_mfma_f32_16x16x32_bf16 v[24:27], v[56:59], v[80:83], v[24:27]
  v_mfma_f32_16x16x32_bf16 v[28:31], v[60:63], v[80:83], v[28:31]
  s_waitcnt vmcnt(2) lgkmcnt(0)
  v_mfma_f32_16x16x32_bf16 v[16:19], v[32:35], v[84:87], v[16:19]
  ds_read_b128 v[48:51], v4 offset:61440
  ds_read_b128 v[52:55], v4 offset:62464
  v_mfma_f32_16x16x32_bf16 v[20:23], v[36:39], v[84:87], v[20:23]
  ds_read_b128 v[56:59], v4 offset:63488
  ds_read_b128 v[60:63], v4 offset:64512
  v_mfma_f32_16x16x32_bf16 v[24:27], v[40:43], v[84:87], v[24:27]
  v_mfma_f32_16x16x32_bf16 v[28:31], v[44:47], v[84:87], v[28:31]
  s_waitcnt vmcnt(1) lgkmcnt(0)
  v_mfma_f32_16x16x32_bf16 v[16:19], v[48:51], v[88:91], v[16:19]
  v_mfma_f32_16x16x32_bf16 v[20:23], v[52:55], v[88:91], v[20:23]
  v_mfma_f32_16x16x32_bf16 v[24:27], v[56:59], v[88:91], v[24:27]
  v_mfma_f32_16x16x32_bf16 v[28:31], v[60:63], v[88:91], v[28:31]
  s_mov_b32 s63, 0x40000
  s_mov_b32 s24, 131072
pollw:
  s_sub_u32 s63, s63, 1
  s_waitcnt vmcnt(0)
  v_and_b32 v244, v244, v245
  v_and_b32 v246, v246, v247
  v_and_b32 v244, v244, v246
  v_cmp_eq_u32 vcc, 0, v244
  s_nop 3
  s_cbranch_scc1 pollwx
  s_cbranch_vccz pollwx
  s_sleep 4
  buffer_load_dwordx4 v[244:247], v240, s[36:39], s24 offen sc1
  s_branch pollw
pollwx:
  s_add_u32 s28, s4, 0x1400000
  s_addc_u32 s29, s5, 0
  s_mov_b32 s30, 0x400000
  s_mov_b32 s31, 0x20000
  s_add_u32 s32, s4, 0x2800000
  s_addc_u32 s33, s5, 0
  s_mov_b32 s34, 0x40000
  s_mov_b32 s35, 0x20000
  s_lshl_b32 s24, s27, 15
  s_lshl_b32 s25, s10, 11
  s_add_u32 s24, s24, s25
  s_lshl_b32 s25, s9, 11
  s_lshl_b32 s26, s10, 7
  s_add_u32 s25, s25, s26
  s_add_u32 s42, s25, 65536
  s_nop 1
  v_lshlrev_b32 v12, 16, v232
  v_and_b32 v13, 0xffff0000, v232
  v_pk_add_f32 v[16:17], v[16:17], v[12:13]
  v_lshlrev_b32 v12, 16, v233
  v_and_b32 v13, 0xffff0000, v233
  v_pk_add_f32 v[18:19], v[18:19], v[12:13]
  v_lshlrev_b32 v12, 16, v234
  v_and_b32 v13, 0xffff0000, v234
  v_pk_add_f32 v[20:21], v[20:21], v[12:13]
  v_lshlrev_b32 v12, 16, v235
  v_and_b32 v13, 0xffff0000, v235
  v_pk_add_f32 v[22:23], v[22:23], v[12:13]
  v_lshlrev_b32 v12, 16, v236
  v_and_b32 v13, 0xffff0000, v236
  v_pk_add_f32 v[24:25], v[24:25], v[12:13]
  v_lshlrev_b32 v12, 16, v237
  v_and_b32 v13, 0xffff0000, v237
  v_pk_add_f32 v[26:27], v[26:27], v[12:13]
  v_lshlrev_b32 v12, 16, v238
  v_and_b32 v13, 0xffff0000, v238
  v_pk_add_f32 v[28:29], v[28:29], v[12:13]
  v_lshlrev_b32 v12, 16, v239
  v_and_b32 v13, 0xffff0000, v239
  v_pk_add_f32 v[30:31], v[30:31], v[12:13]
  v_cvt_pk_bf16_f32 v32, v16, v17
  v_cvt_pk_bf16_f32 v33, v18, v19
  v_cvt_pk_bf16_f32 v34, v20, v21
  v_cvt_pk_bf16_f32 v35, v22, v23
  buffer_store_dwordx4 v[32:35], v3, s[28:31], s24 offen offset:0 sc1
  v_cvt_pk_bf16_f32 v36, v24, v25
  v_cvt_pk_bf16_f32 v37, v26, v27
  v_cvt_pk_bf16_f32 v38, v28, v29
  v_cvt_pk_bf16_f32 v39, v30, v31
  buffer_store_dwordx4 v[36:39], v3, s[28:31], s24 offen offset:1024 sc1
  v_mov_b32 v8, 0
  v_mov_b32 v9, 0
  v_mov_b32 v10, 0
  v_mov_b32 v11, 0
  v_lshlrev_b32 v12, 16, v32
  v_and_b32 v13, 0xffff0000, v32
  v_pk_add_f32 v[8:9], v[8:9], v[12:13]
  v_pk_fma_f32 v[10:11], v[12:13], v[12:13], v[10:11]
  v_lshlrev_b32 v12, 16, v33
  v_and_b32 v13, 0xffff0000, v33
  v_pk_add_f32 v[8:9], v[8:9], v[12:13]
  v_pk_fma_f32 v[10:11], v[12:13], v[12:13], v[10:11]
  v_lshlrev_b32 v12, 16, v34
  v_and_b32 v13, 0xffff0000, v34
  v_pk_add_f32 v[8:9], v[8:9], v[12:13]
  v_pk_fma_f32 v[10:11], v[12:13], v[12:13], v[10:11]
  v_lshlrev_b32 v12, 16, v35
  v_and_b32 v13, 0xffff0000, v35
  v_pk_add_f32 v[8:9], v[8:9], v[12:13]
  v_pk_fma_f32 v[10:11], v[12:13], v[12:13], v[10:11]
  v_lshlrev_b32 v12, 16, v36
  v_and_b32 v13, 0xffff0000, v36
  v_pk_add_f32 v[8:9], v[8:9], v[12:13]
  v_pk_fma_f32 v[10:11], v[12:13], v[12:13], v[10:11]
  v_lshlrev_b32 v12, 16, v37
  v_and_b32 v13, 0xffff0000, v37
  v_pk_add_f32 v[8:9], v[8:9], v[12:13]
  v_pk_fma_f32 v[10:11], v[12:13], v[12:13], v[10:11]
  v_lshlrev_b32 v12, 16, v38
  v_and_b32 v13, 0xffff0000, v38
  v_pk_add_f32 v[8:9], v[8:9], v[12:13]
  v_pk_fma_f32 v[10:11], v[12:13], v[12:13], v[10:11]
  v_lshlrev_b32 v12, 16, v39
  v_and_b32 v13, 0xffff0000, v39
  v_pk_add_f32 v[8:9], v[8:9], v[12:13]
  v_pk_fma_f32 v[10:11], v[12:13], v[12:13], v[10:11]
  v_add_f32 v8, v8, v9
  v_add_f32 v9, v10, v11
  v_mov_b32 v10, v8
  v_mov_b32 v11, v9
  s_nop 1
  v_permlane16_swap_b32 v8, v10
  v_permlane16_swap_b32 v9, v11
  s_nop 1
  v_add_f32 v8, v8, v10
  v_add_f32 v9, v9, v11
  v_mov_b32 v10, v8
  v_mov_b32 v11, v9
  s_nop 1
  v_permlane32_swap_b32 v8, v10
  v_permlane32_swap_b32 v9, v11
  s_nop 1
  v_add_f32 v8, v8, v10
  v_add_f32 v9, v9, v11
  s_lshl_b32 s24, s27, 7
  s_lshl_b32 s25, s10, 14
  s_add_u32 s24, s24, s25
  v_lshlrev_b32 v10, 3, v0
  s_mov_b64 exec, 0xffff
  buffer_store_dwordx2 v[8:9], v10, s[32:35], s24 offen sc1
  s_mov_b64 exec, -1
ffn1:
  s_and_b32 s24, s2, 7
  s_mov_b32 s8, s62
  s_lshr_b32 s25, s2, 3
  s_and_b32 s26, s24, 1
  s_lshl_b32 s26, s26, 3
  s_and_b32 s9, s25, 7
  s_add_u32 s9, s9, s26
  s_lshr_b32 s26, s24, 1
  s_mul_i32 s26, s26, 4
  s_lshr_b32 s10, s25, 3
  s_add_u32 s10, s10, s26
  s_cmp_lt_u32 s8, 4
  s_cbranch_scc1 ffn1_comp
  s_sub_u32 s8, s8, 4
  s_mov_b32 s25, s8
  s_lshl_b32 s24, s9, 3
  s_lshl_b32 s25, s25, 1
  s_add_u32 s24, s24, s25
  s_mul_i32 s24, s24, 32768
  v_lshl_add_u32 v2, v0, 4, s24
  v_add_u32 v3, 32768, v2
  s_mul_i32 s21, s10, 458752
  s_mov_b32 s20, 0
  s_mul_i32 s24, s8, 7168
  v_lshl_add_u32 v4, v0, 4, s24
  v_add_u32 v5, 4096, v4
  s_mul_i32 s44, s8, 4096
  s_mul_i32 s45, s8, 7168
  s_add_u32 s45, s45, 16384
  s_add_u32 s12, s4, 0x1400000
  s_addc_u32 s13, s5, 0
  s_mov_b32 s14, 0x400000
  s_mov_b32 s15, 0x20000
  s_add_u32 s16, s4, 0x3800000
  s_addc_u32 s17, s5, 0
  s_mov_b32 s18, 0x700000
  s_mov_b32 s19, 0x20000
  s_waitcnt vmcnt(0)
  s_barrier
  s_add_u32 m0, s45, 0
  s_nop 0
  buffer_load_dwordx4 v4, s[16:19], s21 offen offset:0 sc1 lds
  buffer_load_dwordx4 v4, s[16:19], s21 offen offset:1024 sc1 lds
  buffer_load_dwordx4 v4, s[16:19], s21 offen offset:2048 sc1 lds
  buffer_load_dwordx4 v4, s[16:19], s21 offen offset:3072 sc1 lds
  s_add_u32 m0, s45, 4096
  s_nop 0
  buffer_load_dwordx4 v5, s[16:19], s21 offen offset:0 sc1 lds
  buffer_load_dwordx4 v5, s[16:19], s21 offen offset:1024 sc1 lds
  buffer_load_dwordx4 v5, s[16:19], s21 offen offset:2048 sc1 lds
  s_add_u32 s21, s21, 28672
  s_add_u32 m0, s45, 45056
  s_nop 0
  buffer_load_dwordx4 v4, s[16:19], s21 offen offset:0 sc1 lds
  buffer_load_dwordx4 v4, s[16:19], s21 offen offset:1024 sc1 lds
  buffer_load_dwordx4 v4, s[16:19], s21 offen offset:2048 sc1 lds
  buffer_load_dwordx4 v4, s[16:19], s21 offen offset:3072 sc1 lds
  s_add_u32 m0, s45, 49152
  s_nop 0
  buffer_load_dwordx4 v5, s[16:19], s21 offen offset:0 sc1 lds
  buffer_load_dwordx4 v5, s[16:19], s21 offen offset:1024 sc1 lds
  buffer_load_dwordx4 v5, s[16:19], s21 offen offset:2048 sc1 lds
  s_add_u32 s21, s21, 28672
  s_barrier
  s_add_u32 m0, s44, 0
  s_nop 0
  buffer_load_dwordx4 v2, s[12:15], s20 offen offset:0 sc1 lds
  buffer_load_dwordx4 v2, s[12:15], s20 offen offset:1024 sc1 lds
  s_add_u32 m0, s44, 2048
  s_nop 0
  buffer_load_dwordx4 v3, s[12:15], s20 offen offset:0 sc1 lds
  buffer_load_dwordx4 v3, s[12:15], s20 offen offset:1024 sc1 lds
  s_add_u32 s20, s20, 2048
  s_add_u32 m0, s44, 45056
  s_nop 0
  buffer_load_dwordx4 v2, s[12:15], s20 offen offset:0 sc1 lds
  buffer_load_dwordx4 v2, s[12:15], s20 offen offset:1024 sc1 lds
  s_add_u32 m0, s44, 47104
  s_nop 0
  buffer_load_dwordx4 v3, s[12:15], s20 offen offset:0 sc1 lds
  buffer_load_dwordx4 v3, s[12:15], s20 offen offset:1024 sc1 lds
  s_add_u32 s20, s20, 2048
  s_waitcnt vmcnt(4)
  s_barrier
  s_mov_b32 s22, 90112
  s_mov_b32 s23, 2
ffn1_ld:
  s_add_u32 s46, s22, s44
  s_add_u32 s47, s22, s45
  s_add_u32 m0, s47, 0
  s_nop 0
  buffer_load_dwordx4 v4, s[16:19], s21 offen offset:0 sc1 lds
  buffer_load_dwordx4 v4, s[16:19], s21 offen offset:1024 sc1 lds
  buffer_load_dwordx4 v4, s[16:19], s21 offen offset:2048 sc1 lds
  buffer_load_dwordx4 v4, s[16:19], s21 offen offset:3072 sc1 lds
  s_add_u32 m0, s47, 4096
  s_nop 0
  buffer_load_dwordx4 v5, s[16:19], s21 offen offset:0 sc1 lds
  buffer_load_dwordx4 v5, s[16:19], s21 offen offset:1024 sc1 lds
  buffer_load_dwordx4 v5, s[16:19], s21 offen offset:2048 sc1 lds
  s_add_u32 s21, s21, 28672
  s_add_u32 m0, s46, 0
  s_nop 0
  buffer_load_dwordx4 v2, s[12:15], s20 offen offset:0 sc1 lds
  buffer_load_dwordx4 v2, s[12:15], s20 offen offset:1024 sc1 lds
  s_add_u32 m0, s46, 2048
  s_nop 0
  buffer_load_dwordx4 v3, s[12:15], s20 offen offset:0 sc1 lds
  buffer_load_dwordx4 v3, s[12:15], s20 offen offset:1024 sc1 lds
  s_add_u32 s20, s20, 2048
  s_add_u32 s22, s22, 45056
  s_cmp_eq_u32 s22, 135168
  s_cselect_b32 s22, 0, s22
  s_add_u32 s23, s23, 1
  s_cmp_lt_u32 s23, 3
  s_cbranch_scc1 ffn1_ld
  s_waitcnt vmcnt(11)
  s_barrier
  s_cmp_lt_u32 s23, 16
  s_cbranch_scc1 ffn1_ld
  s_add_u32 s28, s4, 0x2800000
  s_addc_u32 s29, s5, 0
  s_mov_b32 s30, 0x40000
  s_mov_b32 s31, 0x20000
  s_mov_b32 s32, s94
  s_mov_b32 s33, s95
  s_mov_b32 s34, 0x1c00
  s_mov_b32 s35, 0x20000
  s_add_u32 s36, s4, 0x2900000
  s_addc_u32 s37, s5, 0
  s_mov_b32 s38, 0x1c000
  s_mov_b32 s39, 0x20000
  s_lshl_b32 s24, s9, 10
  s_lshl_b32 s25, s8, 8
  s_add_u32 s24, s24, s25
  v_and_b32 v6, 31, v0
  v_lshrrev_b32 v7, 5, v0
  v_lshlrev_b32 v7, 17, v7
  v_lshl_add_u32 v7, v6, 3, v7
  buffer_load_dwordx2 v[16:17], v7, s[28:31], s24 offen sc1
  s_add_u32 s24, s24, 16384
  buffer_load_dwordx2 v[18:19], v7, s[28:31], s24 offen sc1
  s_add_u32 s24, s24, 16384
  buffer_load_dwordx2 v[20:21], v7, s[28:31], s24 offen sc1
  s_add_u32 s24, s24, 16384
  buffer_load_dwordx2 v[22:23], v7, s[28:31], s24 offen sc1
  s_add_u32 s24, s24, 16384
  buffer_load_dwordx2 v[24:25], v7, s[28:31], s24 offen sc1
  s_add_u32 s24, s24, 16384
  buffer_load_dwordx2 v[26:27], v7, s[28:31], s24 offen sc1
  s_add_u32 s24, s24, 16384
  buffer_load_dwordx2 v[28:29], v7, s[28:31], s24 offen sc1
  s_add_u32 s24, s24, 16384
  buffer_load_dwordx2 v[30:31], v7, s[28:31], s24 offen sc1
  s_add_u32 s24, s24, 16384
  s_mul_i32 s24, s10, 224
  s_lshl_b32 s25, s8, 6
  s_add_u32 s24, s24, s25
  v_add_u32 v8, s24, v0
  v_lshlrev_b32 v9, 1, v8
  v_lshlrev_b32 v8, 2, v8
  buffer_load_ushort v12, v9, s[32:35], 0 offen sc1
  s_mov_b32 s24, 0
  buffer_load_dword v32, v8, s[36:39], s24 offen sc1
  s_add_u32 s24, s24, 14336
  buffer_load_dword v33, v8, s[36:39], s24 offen sc1
  s_add_u32 s24, s24, 14336
  buffer_load_dword v34, v8, s[36:39], s24 offen sc1
  s_add_u32 s24, s24, 14336
  buffer_load_dword v35, v8, s[36:39], s24 offen sc1
  s_add_u32 s24, s24, 14336
  buffer_load_dword v36, v8, s[36:39], s24 offen sc1
  s_add_u32 s24, s24, 14336
  buffer_load_dword v37, v8, s[36:39], s24 offen sc1
  s_add_u32 s24, s24, 14336
  buffer_load_dword v38, v8, s[36:39], s24 offen sc1
  s_add_u32 s24, s24, 14336
  buffer_load_dword v39, v8, s[36:39], s24 offen sc1
  s_add_u32 s24, s24, 14336
  s_waitcnt vmcnt(17)
  s_barrier
  s_waitcnt vmcnt(0)
  v_pk_add_f32 v[16:17], v[16:17], v[18:19]
  v_add_f32 v32, v32, v33
  v_pk_add_f32 v[16:17], v[16:17], v[20:21]
  v_add_f32 v32, v32, v34
  v_pk_add_f32 v[16:17], v[16:17], v[22:23]
  v_add_f32 v32, v32, v35
  v_pk_add_f32 v[16:17], v[16:17], v[24:25]
  v_add_f32 v32, v32, v36
  v_pk_add_f32 v[16:17], v[16:17], v[26:27]
  v_add_f32 v32, v32, v37
  v_pk_add_f32 v[16:17], v[16:17], v[28:29]
  v_add_f32 v32, v32, v38
  v_pk_add_f32 v[16:17], v[16:17], v[30:31]
  v_add_f32 v32, v32, v39
  v_mov_b32 v18, v16
  v_mov_b32 v19, v17
  s_nop 1
  v_permlane32_swap_b32 v16, v18
  v_permlane32_swap_b32 v17, v19
  s_mov_b32 s24, 0x3a800000
  s_mov_b32 s25, s24
  v_pk_add_f32 v[16:17], v[16:17], v[18:19]
  v_pk_mul_f32 v[16:17], v[16:17], s[24:25]
  v_fma_f32 v17, -v16, v16, v17
  v_max_f32 v17, 0, v17
  v_add_f32 v17, 0x3727c5ac, v17
  v_rsq_f32 v18, v17
  s_lshl_b32 s24, s8, 8
  s_add_u32 s24, s24, 160768
  v_mul_f32 v19, v16, v18
  v_sub_f32 v19, 0, v19
  v_lshl_add_u32 v6, v6, 3, s24
  ds_write_b64 v6, v[18:19]
  v_lshlrev_b32 v12, 16, v12
  v_lshl_add_u32 v6, v0, 2, s24
  ds_write_b32 v6, v12 offset:1024
  ds_write_b32 v6, v32 offset:2048
  s_waitcnt lgkmcnt(0)
  s_barrier
  s_lshl_b32 s24, s9, 11
  s_lshl_b32 s25, s10, 7
  s_add_u32 s24, s24, s25
  s_add_u32 s42, s24, 98304
  s_getpc_b64 s[28:29]
pc10:
  s_add_u32 s28, s28, main_go-pc10
  s_addc_u32 s29, s29, (main_go-pc10)>>32
  s_lshr_b32 s30, s2, 3
  s_lshl_b32 s30, s30, 11
  v_lshl_add_u32 v8, v0, 4, s30
  s_mov_b32 s30, main_end-main_go
  s_mov_b32 s31, 0x20000
  buffer_load_dwordx4 v[252:255], v8, s[28:31], 0 offen sc1
  buffer_load_dwordx4 v[252:255], v8, s[28:31], 0 offen offset:1024 sc1
  s_branch ffn2
ffn1_comp:
  s_lshr_b32 s11, s8, 1
  s_and_b32 s3, s8, 1
  v_and_b32 v1, 15, v0
  v_lshrrev_b32 v2, 4, v0
  s_mul_i32 s24, s11, 8192
  v_lshl_add_u32 v3, v0, 4, s24
  s_mul_i32 s24, s3, 7168
  s_add_u32 s24, s24, 16384
  v_lshl_add_u32 v4, v0, 4, s24
  v_mov_b32 v6, v3
  s_lshl_b32 s25, s3, 10
  v_add_u32 v4, s25, v4
  s_mul_i32 s61, s3, 7168
  v_subrev_u32 v5, s61, v4
  v_mov_b32 v7, v4
  s_lshl_b32 s27, s9, 3
  s_mul_i32 s24, s11, 4
  s_add_u32 s27, s27, s24
  v_mov_b32 v16, 0
  v_mov_b32 v17, 0
  v_mov_b32 v18, 0
  v_mov_b32 v19, 0
  v_mov_b32 v20, 0
  v_mov_b32 v21, 0
  v_mov_b32 v22, 0
  v_mov_b32 v23, 0
  v_mov_b32 v24, 0
  v_mov_b32 v25, 0
  v_mov_b32 v26, 0
  v_mov_b32 v27, 0
  v_mov_b32 v28, 0
  v_mov_b32 v29, 0
  v_mov_b32 v30, 0
  v_mov_b32 v31, 0
  v_mov_b32 v32, 0
  v_mov_b32 v33, 0
  v_mov_b32 v34, 0
  v_mov_b32 v35, 0
  v_mov_b32 v36, 0
  v_mov_b32 v37, 0
  v_mov_b32 v38, 0
  v_mov_b32 v39, 0
  v_mov_b32 v40, 0
  v_mov_b32 v41, 0
  v_mov_b32 v42, 0
  v_mov_b32 v43, 0
  v_mov_b32 v44, 0
  v_mov_b32 v45, 0
  v_mov_b32 v46, 0
  v_mov_b32 v47, 0
  v_mov_b32 v48, 0
  v_mov_b32 v49, 0
  v_mov_b32 v50, 0
  v_mov_b32 v51, 0
  v_mov_b32 v52, 0
  v_mov_b32 v53, 0
  v_mov_b32 v54, 0
  v_mov_b32 v55, 0
  v_mov_b32 v56, 0
  v_mov_b32 v57, 0
  v_mov_b32 v58, 0
  v_mov_b32 v59, 0
  v_mov_b32 v60, 0
  v_mov_b32 v61, 0
  v_mov_b32 v62, 0
  v_mov_b32 v63, 0
  v_mov_b32 v64, 0
  v_mov_b32 v65, 0
  v_mov_b32 v66, 0
  v_mov_b32 v67, 0
  v_mov_b32 v68, 0
  v_mov_b32 v69, 0
  v_mov_b32 v70, 0
  v_mov_b32 v71, 0
  v_mov_b32 v72, 0
  v_mov_b32 v73, 0
  v_mov_b32 v74, 0
  v_mov_b32 v75, 0
  v_mov_b32 v76, 0
  v_mov_b32 v77, 0
  v_mov_b32 v78, 0
  v_mov_b32 v79, 0
  v_mov_b32 v80, 0
  v_mov_b32 v81, 0
  v_mov_b32 v82, 0
  v_mov_b32 v83, 0
  v_mov_b32 v84, 0
  v_mov_b32 v85, 0
  v_mov_b32 v86, 0
  v_mov_b32 v87, 0
  v_mov_b32 v88, 0
  v_mov_b32 v89, 0
  v_mov_b32 v90, 0
  v_mov_b32 v91, 0
  v_mov_b32 v92, 0
  v_mov_b32 v93, 0
  v_mov_b32 v94, 0
  v_mov_b32 v95, 0
  v_mov_b32 v96, 0
  v_mov_b32 v97, 0
  v_mov_b32 v98, 0
  v_mov_b32 v99, 0
  v_mov_b32 v100, 0
  v_mov_b32 v101, 0
  v_mov_b32 v102, 0
  v_mov_b32 v103, 0
  v_mov_b32 v104, 0
  v_mov_b32 v105, 0
  v_mov_b32 v106, 0
  v_mov_b32 v107, 0
  v_mov_b32 v108, 0
  v_mov_b32 v109, 0
  v_mov_b32 v110, 0
  v_mov_b32 v111, 0
  v_mov_b32 v112, 0
  v_mov_b32 v113, 0
  v_mov_b32 v114, 0
  v_mov_b32 v115, 0
  v_mov_b32 v116, 0
  v_mov_b32 v117, 0
  v_mov_b32 v118, 0
  v_mov_b32 v119, 0
  v_mov_b32 v120, 0
  v_mov_b32 v121, 0
  v_mov_b32 v122, 0
  v_mov_b32 v123, 0
  v_mov_b32 v124, 0
  v_mov_b32 v125, 0
  v_mov_b32 v126, 0
  v_mov_b32 v127, 0
  s_lshl_b32 s60, s9, 11
  s_add_u32 s60, s60, 65536
  s_waitcnt vmcnt(0)
  s_add_u32 s36, s4, 0x2a00000
  s_addc_u32 s37, s5, 0
  s_mov_b32 s38, 0x40000
  s_mov_b32 s39, 0x20000
  s_barrier
  s_cmp_eq_u32 s62, 0
  s_cbranch_scc0 ho11a
  v_mov_b32 v130, 0
  v_mov_b32 v131, 1
  s_mov_b64 exec, 1
  buffer_store_dword v131, v130, s[36:39], s42 offen sc1
  s_mov_b64 exec, -1
ho11a:
  s_cmp_eq_u32 s62, 1
  s_cbranch_scc0 ho11
  v_and_b32 v128, 15, v0
  v_lshlrev_b32 v128, 7, v128
  s_mov_b32 s63, 0x40000
poll12:
  buffer_load_dword v132, v128, s[36:39], s60 offen sc1
  s_sub_u32 s63, s63, 1
  s_waitcnt vmcnt(0)
  v_cmp_eq_u32 vcc, 0, v132
  s_nop 3
  s_cbranch_scc1 poll12x
  s_cbranch_vccz poll12x
  s_sleep 2
  s_branch poll12
poll12x:
ho11:
  s_barrier
  s_mov_b32 s22, 0
  s_mov_b32 s23, 16
  s_barrier
  ds_read_b128 v[144:147], v7 offset:0
  ds_read_b128 v[128:131], v6 offset:0
  ds_read_b128 v[132:135], v6 offset:2048
  ds_read_b128 v[136:139], v6 offset:4096
  ds_read_b128 v[140:143], v6 offset:6144
  ds_read_b128 v[148:151], v7 offset:1024
  ds_read_b128 v[152:155], v7 offset:2048
  ds_read_b128 v[156:159], v7 offset:3072
  ds_read_b128 v[160:163], v7 offset:4096
  ds_read_b128 v[164:167], v7 offset:5120
  ds_read_b128 v[168:171], v5 offset:6144
  s_getpc_b64 s[28:29]
pc13:
  s_add_u32 s28, s28, main_go-pc13
  s_addc_u32 s29, s29, (main_go-pc13)>>32
  s_lshr_b32 s30, s2, 3
  s_lshl_b32 s30, s30, 11
  v_lshl_add_u32 v8, v0, 4, s30
  s_mov_b32 s30, main_end-main_go
  s_mov_b32 s31, 0x20000
  buffer_load_dwordx4 v[252:255], v8, s[28:31], 0 offen sc1
  buffer_load_dwordx4 v[252:255], v8, s[28:31], 0 offen offset:1024 sc1
  .p2align 5
ffn1_loop:
  s_waitcnt lgkmcnt(0)
  v_mfma_f32_16x16x32_bf16 v[16:19], v[144:147], v[128:131], v[16:19]
  ds_read_b128 v[188:191], v7 offset:14336
  v_mfma_f32_16x16x32_bf16 v[44:47], v[144:147], v[132:135], v[44:47]
  ds_read_b128 v[172:175], v6 offset:1024
  v_mfma_f32_16x16x32_bf16 v[72:75], v[144:147], v[136:139], v[72:75]
  ds_read_b128 v[176:179], v6 offset:3072
  v_mfma_f32_16x16x32_bf16 v[100:103], v[144:147], v[140:143], v[100:103]
  ds_read_b128 v[180:183], v6 offset:5120
  v_mfma_f32_16x16x32_bf16 v[104:107], v[148:151], v[140:143], v[104:107]
  ds_read_b128 v[184:187], v6 offset:7168
  v_mfma_f32_16x16x32_bf16 v[76:79], v[148:151], v[136:139], v[76:79]
  ds_read_b128 v[192:195], v7 offset:15360
  v_mfma_f32_16x16x32_bf16 v[48:51], v[148:151], v[132:135], v[48:51]
  ds_read_b128 v[196:199], v7 offset:16384
  v_mfma_f32_16x16x32_bf16 v[20:23], v[148:151], v[128:131], v[20:23]
  ds_read_b128 v[200:203], v7 offset:17408
  v_mfma_f32_16x16x32_bf16 v[24:27], v[152:155], v[128:131], v[24:27]
  ds_read_b128 v[204:207], v7 offset:18432
  v_mfma_f32_16x16x32_bf16 v[52:55], v[152:155], v[132:135], v[52:55]
  ds_read_b128 v[208:211], v7 offset:19456
  v_mfma_f32_16x16x32_bf16 v[80:83], v[152:155], v[136:139], v[80:83]
  ds_read_b128 v[212:215], v5 offset:20480
  v_mfma_f32_16x16x32_bf16 v[108:111], v[152:155], v[140:143], v[108:111]
  s_add_u32 s22, s22, 45056
  v_mfma_f32_16x16x32_bf16 v[112:115], v[156:159], v[140:143], v[112:115]
  s_cmp_eq_u32 s22, 135168
  v_mfma_f32_16x16x32_bf16 v[84:87], v[156:159], v[136:139], v[84:87]
  s_cselect_b32 s22, 0, s22
  v_mfma_f32_16x16x32_bf16 v[56:59], v[156:159], v[132:135], v[56:59]
  v_add_u32 v6, s22, v3
  v_mfma_f32_16x16x32_bf16 v[28:31], v[156:159], v[128:131], v[28:31]
  v_add_u32 v7, s22, v4
  v_mfma_f32_16x16x32_bf16 v[32:35], v[160:163], v[128:131], v[32:35]
  v_subrev_u32 v5, s61, v7
  v_mfma_f32_16x16x32_bf16 v[60:63], v[160:163], v[132:135], v[60:63]
  v_mfma_f32_16x16x32_bf16 v[88:91], v[160:163], v[136:139], v[88:91]
  v_mfma_f32_16x16x32_bf16 v[116:119], v[160:163], v[140:143], v[116:119]
  v_mfma_f32_16x16x32_bf16 v[120:123], v[164:167], v[140:143], v[120:123]
  v_mfma_f32_16x16x32_bf16 v[92:95], v[164:167], v[136:139], v[92:95]
  v_mfma_f32_16x16x32_bf16 v[64:67], v[164:167], v[132:135], v[64:67]
  v_mfma_f32_16x16x32_bf16 v[36:39], v[164:167], v[128:131], v[36:39]
  v_mfma_f32_16x16x32_bf16 v[40:43], v[168:171], v[128:131], v[40:43]
  v_mfma_f32_16x16x32_bf16 v[68:71], v[168:171], v[132:135], v[68:71]
  v_mfma_f32_16x16x32_bf16 v[96:99], v[168:171], v[136:139], v[96:99]
  v_mfma_f32_16x16x32_bf16 v[124:127], v[168:171], v[140:143], v[124:127]
  s_waitcnt lgkmcnt(0)
  s_barrier
  v_mfma_f32_16x16x32_bf16 v[16:19], v[188:191], v[172:175], v[16:19]
  ds_read_b128 v[144:147], v7 offset:0
  v_mfma_f32_16x16x32_bf16 v[44:47], v[188:191], v[176:179], v[44:47]
  ds_read_b128 v[128:131], v6 offset:0
  v_mfma_f32_16x16x32_bf16 v[72:75], v[188:191], v[180:183], v[72:75]
  ds_read_b128 v[132:135], v6 offset:2048
  v_mfma_f32_16x16x32_bf16 v[100:103], v[188:191], v[184:187], v[100:103]
  ds_read_b128 v[136:139], v6 offset:4096
  v_mfma_f32_16x16x32_bf16 v[104:107], v[192:195], v[184:187], v[104:107]
  ds_read_b128 v[140:143], v6 offset:6144
  v_mfma_f32_16x16x32_bf16 v[76:79], v[192:195], v[180:183], v[76:79]
  ds_read_b128 v[148:151], v7 offset:1024
  v_mfma_f32_16x16x32_bf16 v[48:51], v[192:195], v[176:179], v[48:51]
  ds_read_b128 v[152:155], v7 offset:2048
  v_mfma_f32_16x16x32_bf16 v[20:23], v[192:195], v[172:175], v[20:23]
  ds_read_b128 v[156:159], v7 offset:3072
  v_mfma_f32_16x16x32_bf16 v[24:27], v[196:199], v[172:175], v[24:27]
  ds_read_b128 v[160:163], v7 offset:4096
  v_mfma_f32_16x16x32_bf16 v[52:55], v[196:199], v[176:179], v[52:55]
  ds_read_b128 v[164:167], v7 offset:5120
  v_mfma_f32_16x16x32_bf16 v[80:83], v[196:199], v[180:183], v[80:83]
  ds_read_b128 v[168:171], v5 offset:6144
  v_mfma_f32_16x16x32_bf16 v[108:111], v[196:199], v[184:187], v[108:111]
  v_mfma_f32_16x16x32_bf16 v[112:115], v[200:203], v[184:187], v[112:115]
  v_mfma_f32_16x16x32_bf16 v[84:87], v[200:203], v[180:183], v[84:87]
  v_mfma_f32_16x16x32_bf16 v[56:59], v[200:203], v[176:179], v[56:59]
  v_mfma_f32_16x16x32_bf16 v[28:31], v[200:203], v[172:175], v[28:31]
  v_mfma_f32_16x16x32_bf16 v[32:35], v[204:207], v[172:175], v[32:35]
  v_mfma_f32_16x16x32_bf16 v[60:63], v[204:207], v[176:179], v[60:63]
  v_mfma_f32_16x16x32_bf16 v[88:91], v[204:207], v[180:183], v[88:91]
  v_mfma_f32_16x16x32_bf16 v[116:119], v[204:207], v[184:187], v[116:119]
  v_mfma_f32_16x16x32_bf16 v[120:123], v[208:211], v[184:187], v[120:123]
  v_mfma_f32_16x16x32_bf16 v[92:95], v[208:211], v[180:183], v[92:95]
  v_mfma_f32_16x16x32_bf16 v[64:67], v[208:211], v[176:179], v[64:67]
  v_mfma_f32_16x16x32_bf16 v[36:39], v[208:211], v[172:175], v[36:39]
  v_mfma_f32_16x16x32_bf16 v[40:43], v[212:215], v[172:175], v[40:43]
  v_mfma_f32_16x16x32_bf16 v[68:71], v[212:215], v[176:179], v[68:71]
  v_mfma_f32_16x16x32_bf16 v[96:99], v[212:215], v[180:183], v[96:99]
  v_mfma_f32_16x16x32_bf16 v[124:127], v[212:215], v[184:187], v[124:127]
  s_waitcnt lgkmcnt(0)
  v_mfma_f32_16x16x32_bf16 v[16:19], v[144:147], v[128:131], v[16:19]
  ds_read_b128 v[188:191], v7 offset:14336
  v_mfma_f32_16x16x32_bf16 v[44:47], v[144:147], v[132:135], v[44:47]
  ds_read_b128 v[172:175], v6 offset:1024
  v_mfma_f32_16x16x32_bf16 v[72:75], v[144:147], v[136:139], v[72:75]
  ds_read_b128 v[176:179], v6 offset:3072
  v_mfma_f32_16x16x32_bf16 v[100:103], v[144:147], v[140:143], v[100:103]
  ds_read_b128 v[180:183], v6 offset:5120
  v_mfma_f32_16x16x32_bf16 v[104:107], v[148:151], v[140:143], v[104:107]
  ds_read_b128 v[184:187], v6 offset:7168
  v_mfma_f32_16x16x32_bf16 v[76:79], v[148:151], v[136:139], v[76:79]
  ds_read_b128 v[192:195], v7 offset:15360
  v_mfma_f32_16x16x32_bf16 v[48:51], v[148:151], v[132:135], v[48:51]
  ds_read_b128 v[196:199], v7 offset:16384
  v_mfma_f32_16x16x32_bf16 v[20:23], v[148:151], v[128:131], v[20:23]
  ds_read_b128 v[200:203], v7 offset:17408
  v_mfma_f32_16x16x32_bf16 v[24:27], v[152:155], v[128:131], v[24:27]
  ds_read_b128 v[204:207], v7 offset:18432
  v_mfma_f32_16x16x32_bf16 v[52:55], v[152:155], v[132:135], v[52:55]
  ds_read_b128 v[208:211], v7 offset:19456
  v_mfma_f32_16x16x32_bf16 v[80:83], v[152:155], v[136:139], v[80:83]
  ds_read_b128 v[212:215], v5 offset:20480
  v_mfma_f32_16x16x32_bf16 v[108:111], v[152:155], v[140:143], v[108:111]
  s_add_u32 s22, s22, 45056
  v_mfma_f32_16x16x32_bf16 v[112:115], v[156:159], v[140:143], v[112:115]
  s_cmp_eq_u32 s22, 135168
  v_mfma_f32_16x16x32_bf16 v[84:87], v[156:159], v[136:139], v[84:87]
  s_cselect_b32 s22, 0, s22
  v_mfma_f32_16x16x32_bf16 v[56:59], v[156:159], v[132:135], v[56:59]
  v_add_u32 v6, s22, v3
  v_mfma_f32_16x16x32_bf16 v[28:31], v[156:159], v[128:131], v[28:31]
  v_add_u32 v7, s22, v4
  v_mfma_f32_16x16x32_bf16 v[32:35], v[160:163], v[128:131], v[32:35]
  v_subrev_u32 v5, s61, v7
  v_mfma_f32_16x16x32_bf16 v[60:63], v[160:163], v[132:135], v[60:63]
  v_mfma_f32_16x16x32_bf16 v[88:91], v[160:163], v[136:139], v[88:91]
  v_mfma_f32_16x16x32_bf16 v[116:119], v[160:163], v[140:143], v[116:119]
  v_mfma_f32_16x16x32_bf16 v[120:123], v[164:167], v[140:143], v[120:123]
  v_mfma_f32_16x16x32_bf16 v[92:95], v[164:167], v[136:139], v[92:95]
  v_mfma_f32_16x16x32_bf16 v[64:67], v[164:167], v[132:135], v[64:67]
  v_mfma_f32_16x16x32_bf16 v[36:39], v[164:167], v[128:131], v[36:39]
  v_mfma_f32_16x16x32_bf16 v[40:43], v[168:171], v[128:131], v[40:43]
  v_mfma_f32_16x16x32_bf16 v[68:71], v[168:171], v[132:135], v[68:71]
  v_mfma_f32_16x16x32_bf16 v[96:99], v[168:171], v[136:139], v[96:99]
  v_mfma_f32_16x16x32_bf16 v[124:127], v[168:171], v[140:143], v[124:127]
  s_waitcnt lgkmcnt(0)
  s_barrier
  v_mfma_f32_16x16x32_bf16 v[16:19], v[188:191], v[172:175], v[16:19]
  ds_read_b128 v[144:147], v7 offset:0
  v_mfma_f32_16x16x32_bf16 v[44:47], v[188:191], v[176:179], v[44:47]
  ds_read_b128 v[128:131], v6 offset:0
  v_mfma_f32_16x16x32_bf16 v[72:75], v[188:191], v[180:183], v[72:75]
  ds_read_b128 v[132:135], v6 offset:2048
  v_mfma_f32_16x16x32_bf16 v[100:103], v[188:191], v[184:187], v[100:103]
  ds_read_b128 v[136:139], v6 offset:4096
  v_mfma_f32_16x16x32_bf16 v[104:107], v[192:195], v[184:187], v[104:107]
  ds_read_b128 v[140:143], v6 offset:6144
  v_mfma_f32_16x16x32_bf16 v[76:79], v[192:195], v[180:183], v[76:79]
  ds_read_b128 v[148:151], v7 offset:1024
  v_mfma_f32_16x16x32_bf16 v[48:51], v[192:195], v[176:179], v[48:51]
  ds_read_b128 v[152:155], v7 offset:2048
  v_mfma_f32_16x16x32_bf16 v[20:23], v[192:195], v[172:175], v[20:23]
  ds_read_b128 v[156:159], v7 offset:3072
  v_mfma_f32_16x16x32_bf16 v[24:27], v[196:199], v[172:175], v[24:27]
  ds_read_b128 v[160:163], v7 offset:4096
  v_mfma_f32_16x16x32_bf16 v[52:55], v[196:199], v[176:179], v[52:55]
  ds_read_b128 v[164:167], v7 offset:5120
  v_mfma_f32_16x16x32_bf16 v[80:83], v[196:199], v[180:183], v[80:83]
  ds_read_b128 v[168:171], v5 offset:6144
  v_mfma_f32_16x16x32_bf16 v[108:111], v[196:199], v[184:187], v[108:111]
  s_sub_u32 s23, s23, 2
  v_mfma_f32_16x16x32_bf16 v[112:115], v[200:203], v[184:187], v[112:115]
  s_cmp_lg_u32 s23, 0
  v_mfma_f32_16x16x32_bf16 v[84:87], v[200:203], v[180:183], v[84:87]
  v_mfma_f32_16x16x32_bf16 v[56:59], v[200:203], v[176:179], v[56:59]
  v_mfma_f32_16x16x32_bf16 v[28:31], v[200:203], v[172:175], v[28:31]
  v_mfma_f32_16x16x32_bf16 v[32:35], v[204:207], v[172:175], v[32:35]
  v_mfma_f32_16x16x32_bf16 v[60:63], v[204:207], v[176:179], v[60:63]
  v_mfma_f32_16x16x32_bf16 v[88:91], v[204:207], v[180:183], v[88:91]
  v_mfma_f32_16x16x32_bf16 v[116:119], v[204:207], v[184:187], v[116:119]
  v_mfma_f32_16x16x32_bf16 v[120:123], v[208:211], v[184:187], v[120:123]
  v_mfma_f32_16x16x32_bf16 v[92:95], v[208:211], v[180:183], v[92:95]
  v_mfma_f32_16x16x32_bf16 v[64:67], v[208:211], v[176:179], v[64:67]
  v_mfma_f32_16x16x32_bf16 v[36:39], v[208:211], v[172:175], v[36:39]
  v_mfma_f32_16x16x32_bf16 v[40:43], v[212:215], v[172:175], v[40:43]
  v_mfma_f32_16x16x32_bf16 v[68:71], v[212:215], v[176:179], v[68:71]
  v_mfma_f32_16x16x32_bf16 v[96:99], v[212:215], v[180:183], v[96:99]
  v_mfma_f32_16x16x32_bf16 v[124:127], v[212:215], v[184:187], v[124:127]
  s_cbranch_scc1 ffn1_loop
  s_waitcnt vmcnt(0) lgkmcnt(0)
  s_nop 7
  s_add_u32 s28, s4, 0x1800000
  s_addc_u32 s29, s5, 0
  s_mov_b32 s30, 0xe00000
  s_mov_b32 s31, 0x20000
  s_lshl_b32 s24, s11, 9
  s_add_u32 s24, s24, 160768
  v_lshl_add_u32 v9, v1, 3, s24
  s_lshl_b32 s24, s3, 9
  s_add_u32 s24, s24, 160768
  v_lshl_add_u32 v10, v2, 4, s24
  s_mul_i32 s24, s3, 448
  v_subrev_u32 v11, s24, v10
  ds_read_b64 v[152:153], v9 offset:0
  ds_read_b64 v[154:155], v9 offset:128
  ds_read_b64 v[156:157], v9 offset:256
  ds_read_b64 v[158:159], v9 offset:384
  ds_read_b128 v[160:163], v10 offset:1024
  ds_read_b128 v[188:191], v10 offset:2048
  ds_read_b128 v[164:167], v10 offset:1088
  ds_read_b128 v[192:195], v10 offset:2112
  ds_read_b128 v[168:171], v10 offset:1152
  ds_read_b128 v[196:199], v10 offset:2176
  ds_read_b128 v[172:175], v10 offset:1216
  ds_read_b128 v[200:203], v10 offset:2240
  ds_read_b128 v[176:179], v10 offset:1280
  ds_read_b128 v[204:207], v10 offset:2304
  ds_read_b128 v[180:183], v10 offset:1344
  ds_read_b128 v[208:211], v10 offset:2368
  ds_read_b128 v[184:187], v11 offset:1408
  ds_read_b128 v[212:215], v11 offset:2432
  s_mov_b32 s44, 0xbdd2d3e8
  s_mov_b32 s45, s44
  v_mov_b32 v12, 0xc0135761
  v_mov_b32 v13, v12
  s_mul_i32 s24, s27, 114688
  s_mul_i32 s25, s10, 7168
  s_add_u32 s24, s24, s25
  s_mul_i32 s25, s3, 4096
  s_add_u32 s48, s24, s25
  s_lshl_b32 s25, s3, 9
  s_add_u32 s52, s24, s25
  s_add_u32 s52, s52, 3072
  s_add_u32 s54, s52, 229376
  v_lshlrev_b32 v9, 4, v0
  v_and_b32 v10, 1, v2
  v_mul_u32_u24 v10, 114688, v10
  v_lshl_add_u32 v10, v1, 4, v10
  v_lshrrev_b32 v11, 1, v2
  v_lshl_add_u32 v10, v11, 8, v10
  s_add_u32 s49, s48, 114688
  s_add_u32 s50, s48, 229376
  s_add_u32 s51, s48, 344064
  s_waitcnt lgkmcnt(0)
  v_pk_fma_f32 v[128:129], v[212:213], v[152:153], v[184:185] op_sel:[0,1,0] op_sel_hi:[1,1,1]
  v_pk_fma_f32 v[132:133], v[212:213], v[154:155], v[184:185] op_sel:[0,1,0] op_sel_hi:[1,1,1]
  v_pk_fma_f32 v[130:131], v[214:215], v[152:153], v[186:187] op_sel:[0,1,0] op_sel_hi:[1,1,1]
  v_pk_fma_f32 v[134:135], v[214:215], v[154:155], v[186:187] op_sel:[0,1,0] op_sel_hi:[1,1,1]
  v_pk_fma_f32 v[40:41], v[40:41], v[152:153], v[128:129] op_sel_hi:[1,0,1]
  v_pk_fma_f32 v[68:69], v[68:69], v[154:155], v[132:133] op_sel_hi:[1,0,1]
  v_pk_fma_f32 v[42:43], v[42:43], v[152:153], v[130:131] op_sel_hi:[1,0,1]
  v_pk_fma_f32 v[70:71], v[70:71], v[154:155], v[134:135] op_sel_hi:[1,0,1]
  v_pk_mul_f32 v[128:129], v[40:41], v[40:41]
  v_pk_mul_f32 v[132:133], v[68:69], v[68:69]
  v_pk_mul_f32 v[130:131], v[42:43], v[42:43]
  v_pk_mul_f32 v[134:135], v[70:71], v[70:71]
  v_pk_fma_f32 v[128:129], v[128:129], s[44:45], v[12:13]
  v_pk_fma_f32 v[132:133], v[132:133], s[44:45], v[12:13]
  v_pk_fma_f32 v[130:131], v[130:131], s[44:45], v[12:13]
  v_pk_fma_f32 v[134:135], v[134:135], s[44:45], v[12:13]
  v_pk_mul_f32 v[128:129], v[128:129], v[40:41]
  v_pk_mul_f32 v[132:133], v[132:133], v[68:69]
  v_pk_mul_f32 v[130:131], v[130:131], v[42:43]
  v_pk_mul_f32 v[134:135], v[134:135], v[70:71]
  v_exp_f32 v128, v128
  v_exp_f32 v132, v132
  v_exp_f32 v129, v129
  v_exp_f32 v133, v133
  v_exp_f32 v130, v130
  v_exp_f32 v134, v134
  v_exp_f32 v131, v131
  v_exp_f32 v135, v135
  v_pk_add_f32 v[128:129], v[128:129], 1.0 op_sel_hi:[1,0]
  v_pk_add_f32 v[132:133], v[132:133], 1.0 op_sel_hi:[1,0]
  v_pk_add_f32 v[130:131], v[130:131], 1.0 op_sel_hi:[1,0]
  v_pk_add_f32 v[134:135], v[134:135], 1.0 op_sel_hi:[1,0]
  v_rcp_f32 v128, v128
  v_rcp_f32 v132, v132
  v_rcp_f32 v129, v129
  v_rcp_f32 v133, v133
  v_rcp_f32 v130, v130
  v_rcp_f32 v134, v134
  v_rcp_f32 v131, v131
  v_rcp_f32 v135, v135
  v_pk_mul_f32 v[40:41], v[40:41], v[128:129]
  v_pk_mul_f32 v[68:69], v[68:69], v[132:133]
  v_pk_mul_f32 v[42:43], v[42:43], v[130:131]
  v_pk_mul_f32 v[70:71], v[70:71], v[134:135]
  v_cvt_pk_bf16_f32 v136, v40, v41
  v_cvt_pk_bf16_f32 v137, v42, v43
  v_cvt_pk_bf16_f32 v138, v68, v69
  v_cvt_pk_bf16_f32 v139, v70, v71
  s_nop 1
  v_permlane16_swap_b32 v136, v138
  v_permlane16_swap_b32 v137, v139
  buffer_store_dwordx4 v[136:139], v10, s[28:31], s52 offen sc1
  v_pk_fma_f32 v[128:129], v[212:213], v[156:157], v[184:185] op_sel:[0,1,0] op_sel_hi:[1,1,1]
  v_pk_fma_f32 v[132:133], v[212:213], v[158:159], v[184:185] op_sel:[0,1,0] op_sel_hi:[1,1,1]
  v_pk_fma_f32 v[130:131], v[214:215], v[156:157], v[186:187] op_sel:[0,1,0] op_sel_hi:[1,1,1]
  v_pk_fma_f32 v[134:135], v[214:215], v[158:159], v[186:187] op_sel:[0,1,0] op_sel_hi:[1,1,1]
  v_pk_fma_f32 v[96:97], v[96:97], v[156:157], v[128:129] op_sel_hi:[1,0,1]
  v_pk_fma_f32 v[124:125], v[124:125], v[158:159], v[132:133] op_sel_hi:[1,0,1]
  v_pk_fma_f32 v[98:99], v[98:99], v[156:157], v[130:131] op_sel_hi:[1,0,1]
  v_pk_fma_f32 v[126:127], v[126:127], v[158:159], v[134:135] op_sel_hi:[1,0,1]
  v_pk_mul_f32 v[128:129], v[96:97], v[96:97]
  v_pk_mul_f32 v[132:133], v[124:125], v[124:125]
  v_pk_mul_f32 v[130:131], v[98:99], v[98:99]
  v_pk_mul_f32 v[134:135], v[126:127], v[126:127]
  v_pk_fma_f32 v[128:129], v[128:129], s[44:45], v[12:13]
  v_pk_fma_f32 v[132:133], v[132:133], s[44:45], v[12:13]
  v_pk_fma_f32 v[130:131], v[130:131], s[44:45], v[12:13]
  v_pk_fma_f32 v[134:135], v[134:135], s[44:45], v[12:13]
  v_pk_mul_f32 v[128:129], v[128:129], v[96:97]
  v_pk_mul_f32 v[132:133], v[132:133], v[124:125]
  v_pk_mul_f32 v[130:131], v[130:131], v[98:99]
  v_pk_mul_f32 v[134:135], v[134:135], v[126:127]
  v_exp_f32 v128, v128
  v_exp_f32 v132, v132
  v_exp_f32 v129, v129
  v_exp_f32 v133, v133
  v_exp_f32 v130, v130
  v_exp_f32 v134, v134
  v_exp_f32 v131, v131
  v_exp_f32 v135, v135
  v_pk_add_f32 v[128:129], v[128:129], 1.0 op_sel_hi:[1,0]
  v_pk_add_f32 v[132:133], v[132:133], 1.0 op_sel_hi:[1,0]
  v_pk_add_f32 v[130:131], v[130:131], 1.0 op_sel_hi:[1,0]
  v_pk_add_f32 v[134:135], v[134:135], 1.0 op_sel_hi:[1,0]
  v_rcp_f32 v128, v128
  v_rcp_f32 v132, v132
  v_rcp_f32 v129, v129
  v_rcp_f32 v133, v133
  v_rcp_f32 v130, v130
  v_rcp_f32 v134, v134
  v_rcp_f32 v131, v131
  v_rcp_f32 v135, v135
  v_pk_mul_f32 v[96:97], v[96:97], v[128:129]
  v_pk_mul_f32 v[124:125], v[124:125], v[132:133]
  v_pk_mul_f32 v[98:99], v[98:99], v[130:131]
  v_pk_mul_f32 v[126:127], v[126:127], v[134:135]
  v_cvt_pk_bf16_f32 v140, v96, v97
  v_cvt_pk_bf16_f32 v141, v98, v99
  v_cvt_pk_bf16_f32 v142, v124, v125
  v_cvt_pk_bf16_f32 v143, v126, v127
  s_nop 1
  v_permlane16_swap_b32 v140, v142
  v_permlane16_swap_b32 v141, v143
  buffer_store_dwordx4 v[140:143], v10, s[28:31], s54 offen sc1
  v_pk_fma_f32 v[128:129], v[188:189], v[152:153], v[160:161] op_sel:[0,1,0] op_sel_hi:[1,1,1]
  v_pk_fma_f32 v[132:133], v[192:193], v[152:153], v[164:165] op_sel:[0,1,0] op_sel_hi:[1,1,1]
  v_pk_fma_f32 v[130:131], v[190:191], v[152:153], v[162:163] op_sel:[0,1,0] op_sel_hi:[1,1,1]
  v_pk_fma_f32 v[134:135], v[194:195], v[152:153], v[166:167] op_sel:[0,1,0] op_sel_hi:[1,1,1]
  v_pk_fma_f32 v[16:17], v[16:17], v[152:153], v[128:129] op_sel_hi:[1,0,1]
  v_pk_fma_f32 v[20:21], v[20:21], v[152:153], v[132:133] op_sel_hi:[1,0,1]
  v_pk_fma_f32 v[18:19], v[18:19], v[152:153], v[130:131] op_sel_hi:[1,0,1]
  v_pk_fma_f32 v[22:23], v[22:23], v[152:153], v[134:135] op_sel_hi:[1,0,1]
  v_pk_mul_f32 v[128:129], v[16:17], v[16:17]
  v_pk_mul_f32 v[132:133], v[20:21], v[20:21]
  v_pk_mul_f32 v[130:131], v[18:19], v[18:19]
  v_pk_mul_f32 v[134:135], v[22:23], v[22:23]
  v_pk_fma_f32 v[128:129], v[128:129], s[44:45], v[12:13]
  v_pk_fma_f32 v[132:133], v[132:133], s[44:45], v[12:13]
  v_pk_fma_f32 v[130:131], v[130:131], s[44:45], v[12:13]
  v_pk_fma_f32 v[134:135], v[134:135], s[44:45], v[12:13]
  v_pk_mul_f32 v[128:129], v[128:129], v[16:17]
  v_pk_mul_f32 v[132:133], v[132:133], v[20:21]
  v_pk_mul_f32 v[130:131], v[130:131], v[18:19]
  v_pk_mul_f32 v[134:135], v[134:135], v[22:23]
  v_exp_f32 v128, v128
  v_exp_f32 v132, v132
  v_exp_f32 v129, v129
  v_exp_f32 v133, v133
  v_exp_f32 v130, v130
  v_exp_f32 v134, v134
  v_exp_f32 v131, v131
  v_exp_f32 v135, v135
  v_pk_add_f32 v[128:129], v[128:129], 1.0 op_sel_hi:[1,0]
  v_pk_add_f32 v[132:133], v[132:133], 1.0 op_sel_hi:[1,0]
  v_pk_add_f32 v[130:131], v[130:131], 1.0 op_sel_hi:[1,0]
  v_pk_add_f32 v[134:135], v[134:135], 1.0 op_sel_hi:[1,0]
  v_rcp_f32 v128, v128
  v_rcp_f32 v132, v132
  v_rcp_f32 v129, v129
  v_rcp_f32 v133, v133
  v_rcp_f32 v130, v130
  v_rcp_f32 v134, v134
  v_rcp_f32 v131, v131
  v_rcp_f32 v135, v135
  v_pk_mul_f32 v[16:17], v[16:17], v[128:129]
  v_pk_mul_f32 v[20:21], v[20:21], v[132:133]
  v_pk_mul_f32 v[18:19], v[18:19], v[130:131]
  v_pk_mul_f32 v[22:23], v[22:23], v[134:135]
  v_cvt_pk_bf16_f32 v144, v16, v17
  v_cvt_pk_bf16_f32 v145, v18, v19
  v_cvt_pk_bf16_f32 v146, v20, v21
  v_cvt_pk_bf16_f32 v147, v22, v23
  buffer_store_dwordx4 v[144:147], v9, s[28:31], s48 offen offset:0 sc1
  v_pk_fma_f32 v[128:129], v[196:197], v[152:153], v[168:169] op_sel:[0,1,0] op_sel_hi:[1,1,1]
  v_pk_fma_f32 v[132:133], v[200:201], v[152:153], v[172:173] op_sel:[0,1,0] op_sel_hi:[1,1,1]
  v_pk_fma_f32 v[130:131], v[198:199], v[152:153], v[170:171] op_sel:[0,1,0] op_sel_hi:[1,1,1]
  v_pk_fma_f32 v[134:135], v[202:203], v[152:153], v[174:175] op_sel:[0,1,0] op_sel_hi:[1,1,1]
  v_pk_fma_f32 v[24:25], v[24:25], v[152:153], v[128:129] op_sel_hi:[1,0,1]
  v_pk_fma_f32 v[28:29], v[28:29], v[152:153], v[132:133] op_sel_hi:[1,0,1]
  v_pk_fma_f32 v[26:27], v[26:27], v[152:153], v[130:131] op_sel_hi:[1,0,1]
  v_pk_fma_f32 v[30:31], v[30:31], v[152:153], v[134:135] op_sel_hi:[1,0,1]
  v_pk_mul_f32 v[128:129], v[24:25], v[24:25]
  v_pk_mul_f32 v[132:133], v[28:29], v[28:29]
  v_pk_mul_f32 v[130:131], v[26:27], v[26:27]
  v_pk_mul_f32 v[134:135], v[30:31], v[30:31]
  v_pk_fma_f32 v[128:129], v[128:129], s[44:45], v[12:13]
  v_pk_fma_f32 v[132:133], v[132:133], s[44:45], v[12:13]
  v_pk_fma_f32 v[130:131], v[130:131], s[44:45], v[12:13]
  v_pk_fma_f32 v[134:135], v[134:135], s[44:45], v[12:13]
  v_pk_mul_f32 v[128:129], v[128:129], v[24:25]
  v_pk_mul_f32 v[132:133], v[132:133], v[28:29]
  v_pk_mul_f32 v[130:131], v[130:131], v[26:27]
  v_pk_mul_f32 v[134:135], v[134:135], v[30:31]
  v_exp_f32 v128, v128
  v_exp_f32 v132, v132
  v_exp_f32 v129, v129
  v_exp_f32 v133, v133
  v_exp_f32 v130, v130
  v_exp_f32 v134, v134
  v_exp_f32 v131, v131
  v_exp_f32 v135, v135
  v_pk_add_f32 v[128:129], v[128:129], 1.0 op_sel_hi:[1,0]
  v_pk_add_f32 v[132:133], v[132:133], 1.0 op_sel_hi:[1,0]
  v_pk_add_f32 v[130:131], v[130:131], 1.0 op_sel_hi:[1,0]
  v_pk_add_f32 v[134:135], v[134:135], 1.0 op_sel_hi:[1,0]
  v_rcp_f32 v128, v128
  v_rcp_f32 v132, v132
  v_rcp_f32 v129, v129
  v_rcp_f32 v133, v133
  v_rcp_f32 v130, v130
  v_rcp_f32 v134, v134
  v_rcp_f32 v131, v131
  v_rcp_f32 v135, v135
  v_pk_mul_f32 v[24:25], v[24:25], v[128:129]
  v_pk_mul_f32 v[28:29], v[28:29], v[132:133]
  v_pk_mul_f32 v[26:27], v[26:27], v[130:131]
  v_pk_mul_f32 v[30:31], v[30:31], v[134:135]
  v_cvt_pk_bf16_f32 v148, v24, v25
  v_cvt_pk_bf16_f32 v149, v26, v27
  v_cvt_pk_bf16_f32 v150, v28, v29
  v_cvt_pk_bf16_f32 v151, v30, v31
  buffer_store_dwordx4 v[148:151], v9, s[28:31], s48 offen offset:1024 sc1
  v_pk_fma_f32 v[128:129], v[204:205], v[152:153], v[176:177] op_sel:[0,1,0] op_sel_hi:[1,1,1]
  v_pk_fma_f32 v[132:133], v[208:209], v[152:153], v[180:181] op_sel:[0,1,0] op_sel_hi:[1,1,1]
  v_pk_fma_f32 v[130:131], v[206:207], v[152:153], v[178:179] op_sel:[0,1,0] op_sel_hi:[1,1,1]
  v_pk_fma_f32 v[134:135], v[210:211], v[152:153], v[182:183] op_sel:[0,1,0] op_sel_hi:[1,1,1]
  v_pk_fma_f32 v[32:33], v[32:33], v[152:153], v[128:129] op_sel_hi:[1,0,1]
  v_pk_fma_f32 v[36:37], v[36:37], v[152:153], v[132:133] op_sel_hi:[1,0,1]
  v_pk_fma_f32 v[34:35], v[34:35], v[152:153], v[130:131] op_sel_hi:[1,0,1]
  v_pk_fma_f32 v[38:39], v[38:39], v[152:153], v[134:135] op_sel_hi:[1,0,1]
  v_pk_mul_f32 v[128:129], v[32:33], v[32:33]
  v_pk_mul_f32 v[132:133], v[36:37], v[36:37]
  v_pk_mul_f32 v[130:131], v[34:35], v[34:35]
  v_pk_mul_f32 v[134:135], v[38:39], v[38:39]
  v_pk_fma_f32 v[128:129], v[128:129], s[44:45], v[12:13]
  v_pk_fma_f32 v[132:133], v[132:133], s[44:45], v[12:13]
  v_pk_fma_f32 v[130:131], v[130:131], s[44:45], v[12:13]
  v_pk_fma_f32 v[134:135], v[134:135], s[44:45], v[12:13]
  v_pk_mul_f32 v[128:129], v[128:129], v[32:33]
  v_pk_mul_f32 v[132:133], v[132:133], v[36:37]
  v_pk_mul_f32 v[130:131], v[130:131], v[34:35]
  v_pk_mul_f32 v[134:135], v[134:135], v[38:39]
  v_exp_f32 v128, v128
  v_exp_f32 v132, v132
  v_exp_f32 v129, v129
  v_exp_f32 v133, v133
  v_exp_f32 v130, v130
  v_exp_f32 v134, v134
  v_exp_f32 v131, v131
  v_exp_f32 v135, v135
  v_pk_add_f32 v[128:129], v[128:129], 1.0 op_sel_hi:[1,0]
  v_pk_add_f32 v[132:133], v[132:133], 1.0 op_sel_hi:[1,0]
  v_pk_add_f32 v[130:131], v[130:131], 1.0 op_sel_hi:[1,0]
  v_pk_add_f32 v[134:135], v[134:135], 1.0 op_sel_hi:[1,0]
  v_rcp_f32 v128, v128
  v_rcp_f32 v132, v132
  v_rcp_f32 v129, v129
  v_rcp_f32 v133, v133
  v_rcp_f32 v130, v130
  v_rcp_f32 v134, v134
  v_rcp_f32 v131, v131
  v_rcp_f32 v135, v135
  v_pk_mul_f32 v[32:33], v[32:33], v[128:129]
  v_pk_mul_f32 v[36:37], v[36:37], v[132:133]
  v_pk_mul_f32 v[34:35], v[34:35], v[130:131]
  v_pk_mul_f32 v[38:39], v[38:39], v[134:135]
  v_cvt_pk_bf16_f32 v136, v32, v33
  v_cvt_pk_bf16_f32 v137, v34, v35
  v_cvt_pk_bf16_f32 v138, v36, v37
  v_cvt_pk_bf16_f32 v139, v38, v39
  buffer_store_dwordx4 v[136:139], v9, s[28:31], s48 offen offset:2048 sc1
  v_pk_fma_f32 v[128:129], v[188:189], v[154:155], v[160:161] op_sel:[0,1,0] op_sel_hi:[1,1,1]
  v_pk_fma_f32 v[132:133], v[192:193], v[154:155], v[164:165] op_sel:[0,1,0] op_sel_hi:[1,1,1]
  v_pk_fma_f32 v[130:131], v[190:191], v[154:155], v[162:163] op_sel:[0,1,0] op_sel_hi:[1,1,1]
  v_pk_fma_f32 v[134:135], v[194:195], v[154:155], v[166:167] op_sel:[0,1,0] op_sel_hi:[1,1,1]
  v_pk_fma_f32 v[44:45], v[44:45], v[154:155], v[128:129] op_sel_hi:[1,0,1]
  v_pk_fma_f32 v[48:49], v[48:49], v[154:155], v[132:133] op_sel_hi:[1,0,1]
  v_pk_fma_f32 v[46:47], v[46:47], v[154:155], v[130:131] op_sel_hi:[1,0,1]
  v_pk_fma_f32 v[50:51], v[50:51], v[154:155], v[134:135] op_sel_hi:[1,0,1]
  v_pk_mul_f32 v[128:129], v[44:45], v[44:45]
  v_pk_mul_f32 v[132:133], v[48:49], v[48:49]
  v_pk_mul_f32 v[130:131], v[46:47], v[46:47]
  v_pk_mul_f32 v[134:135], v[50:51], v[50:51]
  v_pk_fma_f32 v[128:129], v[128:129], s[44:45], v[12:13]
  v_pk_fma_f32 v[132:133], v[132:133], s[44:45], v[12:13]
  v_pk_fma_f32 v[130:131], v[130:131], s[44:45], v[12:13]
  v_pk_fma_f32 v[134:135], v[134:135], s[44:45], v[12:13]
  v_pk_mul_f32 v[128:129], v[128:129], v[44:45]
  v_pk_mul_f32 v[132:133], v[132:133], v[48:49]
  v_pk_mul_f32 v[130:131], v[130:131], v[46:47]
  v_pk_mul_f32 v[134:135], v[134:135], v[50:51]
  v_exp_f32 v128, v128
  v_exp_f32 v132, v132
  v_exp_f32 v129, v129
  v_exp_f32 v133, v133
  v_exp_f32 v130, v130
  v_exp_f32 v134, v134
  v_exp_f32 v131, v131
  v_exp_f32 v135, v135
  v_pk_add_f32 v[128:129], v[128:129], 1.0 op_sel_hi:[1,0]
  v_pk_add_f32 v[132:133], v[132:133], 1.0 op_sel_hi:[1,0]
  v_pk_add_f32 v[130:131], v[130:131], 1.0 op_sel_hi:[1,0]
  v_pk_add_f32 v[134:135], v[134:135], 1.0 op_sel_hi:[1,0]
  v_rcp_f32 v128, v128
  v_rcp_f32 v132, v132
  v_rcp_f32 v129, v129
  v_rcp_f32 v133, v133
  v_rcp_f32 v130, v130
  v_rcp_f32 v134, v134
  v_rcp_f32 v131, v131
  v_rcp_f32 v135, v135
  v_pk_mul_f32 v[44:45], v[44:45], v[128:129]
  v_pk_mul_f32 v[48:49], v[48:49], v[132:133]
  v_pk_mul_f32 v[46:47], v[46:47], v[130:131]
  v_pk_mul_f32 v[50:51], v[50:51], v[134:135]
  v_cvt_pk_bf16_f32 v140, v44, v45
  v_cvt_pk_bf16_f32 v141, v46, v47
  v_cvt_pk_bf16_f32 v142, v48, v49
  v_cvt_pk_bf16_f32 v143, v50, v51
  buffer_store_dwordx4 v[140:143], v9, s[28:31], s49 offen offset:0 sc1
  v_pk_fma_f32 v[128:129], v[196:197], v[154:155], v[168:169] op_sel:[0,1,0] op_sel_hi:[1,1,1]
  v_pk_fma_f32 v[132:133], v[200:201], v[154:155], v[172:173] op_sel:[0,1,0] op_sel_hi:[1,1,1]
  v_pk_fma_f32 v[130:131], v[198:199], v[154:155], v[170:171] op_sel:[0,1,0] op_sel_hi:[1,1,1]
  v_pk_fma_f32 v[134:135], v[202:203], v[154:155], v[174:175] op_sel:[0,1,0] op_sel_hi:[1,1,1]
  v_pk_fma_f32 v[52:53], v[52:53], v[154:155], v[128:129] op_sel_hi:[1,0,1]
  v_pk_fma_f32 v[56:57], v[56:57], v[154:155], v[132:133] op_sel_hi:[1,0,1]
  v_pk_fma_f32 v[54:55], v[54:55], v[154:155], v[130:131] op_sel_hi:[1,0,1]
  v_pk_fma_f32 v[58:59], v[58:59], v[154:155], v[134:135] op_sel_hi:[1,0,1]
  v_pk_mul_f32 v[128:129], v[52:53], v[52:53]
  v_pk_mul_f32 v[132:133], v[56:57], v[56:57]
  v_pk_mul_f32 v[130:131], v[54:55], v[54:55]
  v_pk_mul_f32 v[134:135], v[58:59], v[58:59]
  v_pk_fma_f32 v[128:129], v[128:129], s[44:45], v[12:13]
  v_pk_fma_f32 v[132:133], v[132:133], s[44:45], v[12:13]
  v_pk_fma_f32 v[130:131], v[130:131], s[44:45], v[12:13]
  v_pk_fma_f32 v[134:135], v[134:135], s[44:45], v[12:13]
  v_pk_mul_f32 v[128:129], v[128:129], v[52:53]
  v_pk_mul_f32 v[132:133], v[132:133], v[56:57]
  v_pk_mul_f32 v[130:131], v[130:131], v[54:55]
  v_pk_mul_f32 v[134:135], v[134:135], v[58:59]
  v_exp_f32 v128, v128
  v_exp_f32 v132, v132
  v_exp_f32 v129, v129
  v_exp_f32 v133, v133
  v_exp_f32 v130, v130
  v_exp_f32 v134, v134
  v_exp_f32 v131, v131
  v_exp_f32 v135, v135
  v_pk_add_f32 v[128:129], v[128:129], 1.0 op_sel_hi:[1,0]
  v_pk_add_f32 v[132:133], v[132:133], 1.0 op_sel_hi:[1,0]
  v_pk_add_f32 v[130:131], v[130:131], 1.0 op_sel_hi:[1,0]
  v_pk_add_f32 v[134:135], v[134:135], 1.0 op_sel_hi:[1,0]
  v_rcp_f32 v128, v128
  v_rcp_f32 v132, v132
  v_rcp_f32 v129, v129
  v_rcp_f32 v133, v133
  v_rcp_f32 v130, v130
  v_rcp_f32 v134, v134
  v_rcp_f32 v131, v131
  v_rcp_f32 v135, v135
  v_pk_mul_f32 v[52:53], v[52:53], v[128:129]
  v_pk_mul_f32 v[56:57], v[56:57], v[132:133]
  v_pk_mul_f32 v[54:55], v[54:55], v[130:131]
  v_pk_mul_f32 v[58:59], v[58:59], v[134:135]
  v_cvt_pk_bf16_f32 v144, v52, v53
  v_cvt_pk_bf16_f32 v145, v54, v55
  v_cvt_pk_bf16_f32 v146, v56, v57
  v_cvt_pk_bf16_f32 v147, v58, v59
  buffer_store_dwordx4 v[144:147], v9, s[28:31], s49 offen offset:1024 sc1
  v_pk_fma_f32 v[128:129], v[204:205], v[154:155], v[176:177] op_sel:[0,1,0] op_sel_hi:[1,1,1]
  v_pk_fma_f32 v[132:133], v[208:209], v[154:155], v[180:181] op_sel:[0,1,0] op_sel_hi:[1,1,1]
  v_pk_fma_f32 v[130:131], v[206:207], v[154:155], v[178:179] op_sel:[0,1,0] op_sel_hi:[1,1,1]
  v_pk_fma_f32 v[134:135], v[210:211], v[154:155], v[182:183] op_sel:[0,1,0] op_sel_hi:[1,1,1]
  v_pk_fma_f32 v[60:61], v[60:61], v[154:155], v[128:129] op_sel_hi:[1,0,1]
  v_pk_fma_f32 v[64:65], v[64:65], v[154:155], v[132:133] op_sel_hi:[1,0,1]
  v_pk_fma_f32 v[62:63], v[62:63], v[154:155], v[130:131] op_sel_hi:[1,0,1]
  v_pk_fma_f32 v[66:67], v[66:67], v[154:155], v[134:135] op_sel_hi:[1,0,1]
  v_pk_mul_f32 v[128:129], v[60:61], v[60:61]
  v_pk_mul_f32 v[132:133], v[64:65], v[64:65]
  v_pk_mul_f32 v[130:131], v[62:63], v[62:63]
  v_pk_mul_f32 v[134:135], v[66:67], v[66:67]
  v_pk_fma_f32 v[128:129], v[128:129], s[44:45], v[12:13]
  v_pk_fma_f32 v[132:133], v[132:133], s[44:45], v[12:13]
  v_pk_fma_f32 v[130:131], v[130:131], s[44:45], v[12:13]
  v_pk_fma_f32 v[134:135], v[134:135], s[44:45], v[12:13]
  v_pk_mul_f32 v[128:129], v[128:129], v[60:61]
  v_pk_mul_f32 v[132:133], v[132:133], v[64:65]
  v_pk_mul_f32 v[130:131], v[130:131], v[62:63]
  v_pk_mul_f32 v[134:135], v[134:135], v[66:67]
  v_exp_f32 v128, v128
  v_exp_f32 v132, v132
  v_exp_f32 v129, v129
  v_exp_f32 v133, v133
  v_exp_f32 v130, v130
  v_exp_f32 v134, v134
  v_exp_f32 v131, v131
  v_exp_f32 v135, v135
  v_pk_add_f32 v[128:129], v[128:129], 1.0 op_sel_hi:[1,0]
  v_pk_add_f32 v[132:133], v[132:133], 1.0 op_sel_hi:[1,0]
  v_pk_add_f32 v[130:131], v[130:131], 1.0 op_sel_hi:[1,0]
  v_pk_add_f32 v[134:135], v[134:135], 1.0 op_sel_hi:[1,0]
  v_rcp_f32 v128, v128
  v_rcp_f32 v132, v132
  v_rcp_f32 v129, v129
  v_rcp_f32 v133, v133
  v_rcp_f32 v130, v130
  v_rcp_f32 v134, v134
  v_rcp_f32 v131, v131
  v_rcp_f32 v135, v135
  v_pk_mul_f32 v[60:61], v[60:61], v[128:129]
  v_pk_mul_f32 v[64:65], v[64:65], v[132:133]
  v_pk_mul_f32 v[62:63], v[62:63], v[130:131]
  v_pk_mul_f32 v[66:67], v[66:67], v[134:135]
  v_cvt_pk_bf16_f32 v148, v60, v61
  v_cvt_pk_bf16_f32 v149, v62, v63
  v_cvt_pk_bf16_f32 v150, v64, v65
  v_cvt_pk_bf16_f32 v151, v66, v67
  buffer_store_dwordx4 v[148:151], v9, s[28:31], s49 offen offset:2048 sc1
  v_pk_fma_f32 v[128:129], v[188:189], v[156:157], v[160:161] op_sel:[0,1,0] op_sel_hi:[1,1,1]
  v_pk_fma_f32 v[132:133], v[192:193], v[156:157], v[164:165] op_sel:[0,1,0] op_sel_hi:[1,1,1]
  v_pk_fma_f32 v[130:131], v[190:191], v[156:157], v[162:163] op_sel:[0,1,0] op_sel_hi:[1,1,1]
  v_pk_fma_f32 v[134:135], v[194:195], v[156:157], v[166:167] op_sel:[0,1,0] op_sel_hi:[1,1,1]
  v_pk_fma_f32 v[72:73], v[72:73], v[156:157], v[128:129] op_sel_hi:[1,0,1]
  v_pk_fma_f32 v[76:77], v[76:77], v[156:157], v[132:133] op_sel_hi:[1,0,1]
  v_pk_fma_f32 v[74:75], v[74:75], v[156:157], v[130:131] op_sel_hi:[1,0,1]
  v_pk_fma_f32 v[78:79], v[78:79], v[156:157], v[134:135] op_sel_hi:[1,0,1]
  v_pk_mul_f32 v[128:129], v[72:73], v[72:73]
  v_pk_mul_f32 v[132:133], v[76:77], v[76:77]
  v_pk_mul_f32 v[130:131], v[74:75], v[74:75]
  v_pk_mul_f32 v[134:135], v[78:79], v[78:79]
  v_pk_fma_f32 v[128:129], v[128:129], s[44:45], v[12:13]
  v_pk_fma_f32 v[132:133], v[132:133], s[44:45], v[12:13]
  v_pk_fma_f32 v[130:131], v[130:131], s[44:45], v[12:13]
  v_pk_fma_f32 v[134:135], v[134:135], s[44:45], v[12:13]
  v_pk_mul_f32 v[128:129], v[128:129], v[72:73]
  v_pk_mul_f32 v[132:133], v[132:133], v[76:77]
  v_pk_mul_f32 v[130:131], v[130:131], v[74:75]
  v_pk_mul_f32 v[134:135], v[134:135], v[78:79]
  v_exp_f32 v128, v128
  v_exp_f32 v132, v132
  v_exp_f32 v129, v129
  v_exp_f32 v133, v133
  v_exp_f32 v130, v130
  v_exp_f32 v134, v134
  v_exp_f32 v131, v131
  v_exp_f32 v135, v135
  v_pk_add_f32 v[128:129], v[128:129], 1.0 op_sel_hi:[1,0]
  v_pk_add_f32 v[132:133], v[132:133], 1.0 op_sel_hi:[1,0]
  v_pk_add_f32 v[130:131], v[130:131], 1.0 op_sel_hi:[1,0]
  v_pk_add_f32 v[134:135], v[134:135], 1.0 op_sel_hi:[1,0]
  v_rcp_f32 v128, v128
  v_rcp_f32 v132, v132
  v_rcp_f32 v129, v129
  v_rcp_f32 v133, v133
  v_rcp_f32 v130, v130
  v_rcp_f32 v134, v134
  v_rcp_f32 v131, v131
  v_rcp_f32 v135, v135
  v_pk_mul_f32 v[72:73], v[72:73], v[128:129]
  v_pk_mul_f32 v[76:77], v[76:77], v[132:133]
  v_pk_mul_f32 v[74:75], v[74:75], v[130:131]
  v_pk_mul_f32 v[78:79], v[78:79], v[134:135]
  v_cvt_pk_bf16_f32 v136, v72, v73
  v_cvt_pk_bf16_f32 v137, v74, v75
  v_cvt_pk_bf16_f32 v138, v76, v77
  v_cvt_pk_bf16_f32 v139, v78, v79
  buffer_store_dwordx4 v[136:139], v9, s[28:31], s50 offen offset:0 sc1
  v_pk_fma_f32 v[128:129], v[196:197], v[156:157], v[168:169] op_sel:[0,1,0] op_sel_hi:[1,1,1]
  v_pk_fma_f32 v[132:133], v[200:201], v[156:157], v[172:173] op_sel:[0,1,0] op_sel_hi:[1,1,1]
  v_pk_fma_f32 v[130:131], v[198:199], v[156:157], v[170:171] op_sel:[0,1,0] op_sel_hi:[1,1,1]
  v_pk_fma_f32 v[134:135], v[202:203], v[156:157], v[174:175] op_sel:[0,1,0] op_sel_hi:[1,1,1]
  v_pk_fma_f32 v[80:81], v[80:81], v[156:157], v[128:129] op_sel_hi:[1,0,1]
  v_pk_fma_f32 v[84:85], v[84:85], v[156:157], v[132:133] op_sel_hi:[1,0,1]
  v_pk_fma_f32 v[82:83], v[82:83], v[156:157], v[130:131] op_sel_hi:[1,0,1]
  v_pk_fma_f32 v[86:87], v[86:87], v[156:157], v[134:135] op_sel_hi:[1,0,1]
  v_pk_mul_f32 v[128:129], v[80:81], v[80:81]
  v_pk_mul_f32 v[132:133], v[84:85], v[84:85]
  v_pk_mul_f32 v[130:131], v[82:83], v[82:83]
  v_pk_mul_f32 v[134:135], v[86:87], v[86:87]
  v_pk_fma_f32 v[128:129], v[128:129], s[44:45], v[12:13]
  v_pk_fma_f32 v[132:133], v[132:133], s[44:45], v[12:13]
  v_pk_fma_f32 v[130:131], v[130:131], s[44:45], v[12:13]
  v_pk_fma_f32 v[134:135], v[134:135], s[44:45], v[12:13]
  v_pk_mul_f32 v[128:129], v[128:129], v[80:81]
  v_pk_mul_f32 v[132:133], v[132:133], v[84:85]
  v_pk_mul_f32 v[130:131], v[130:131], v[82:83]
  v_pk_mul_f32 v[134:135], v[134:135], v[86:87]
  v_exp_f32 v128, v128
  v_exp_f32 v132, v132
  v_exp_f32 v129, v129
  v_exp_f32 v133, v133
  v_exp_f32 v130, v130
  v_exp_f32 v134, v134
  v_exp_f32 v131, v131
  v_exp_f32 v135, v135
  v_pk_add_f32 v[128:129], v[128:129], 1.0 op_sel_hi:[1,0]
  v_pk_add_f32 v[132:133], v[132:133], 1.0 op_sel_hi:[1,0]
  v_pk_add_f32 v[130:131], v[130:131], 1.0 op_sel_hi:[1,0]
  v_pk_add_f32 v[134:135], v[134:135], 1.0 op_sel_hi:[1,0]
  v_rcp_f32 v128, v128
  v_rcp_f32 v132, v132
  v_rcp_f32 v129, v129
  v_rcp_f32 v133, v133
  v_rcp_f32 v130, v130
  v_rcp_f32 v134, v134
  v_rcp_f32 v131, v131
  v_rcp_f32 v135, v135
  v_pk_mul_f32 v[80:81], v[80:81], v[128:129]
  v_pk_mul_f32 v[84:85], v[84:85], v[132:133]
  v_pk_mul_f32 v[82:83], v[82:83], v[130:131]
  v_pk_mul_f32 v[86:87], v[86:87], v[134:135]
  v_cvt_pk_bf16_f32 v140, v80, v81
  v_cvt_pk_bf16_f32 v141, v82, v83
  v_cvt_pk_bf16_f32 v142, v84, v85
  v_cvt_pk_bf16_f32 v143, v86, v87
  buffer_store_dwordx4 v[140:143], v9, s[28:31], s50 offen offset:1024 sc1
  v_pk_fma_f32 v[128:129], v[204:205], v[156:157], v[176:177] op_sel:[0,1,0] op_sel_hi:[1,1,1]
  v_pk_fma_f32 v[132:133], v[208:209], v[156:157], v[180:181] op_sel:[0,1,0] op_sel_hi:[1,1,1]
  v_pk_fma_f32 v[130:131], v[206:207], v[156:157], v[178:179] op_sel:[0,1,0] op_sel_hi:[1,1,1]
  v_pk_fma_f32 v[134:135], v[210:211], v[156:157], v[182:183] op_sel:[0,1,0] op_sel_hi:[1,1,1]
  v_pk_fma_f32 v[88:89], v[88:89], v[156:157], v[128:129] op_sel_hi:[1,0,1]
  v_pk_fma_f32 v[92:93], v[92:93], v[156:157], v[132:133] op_sel_hi:[1,0,1]
  v_pk_fma_f32 v[90:91], v[90:91], v[156:157], v[130:131] op_sel_hi:[1,0,1]
  v_pk_fma_f32 v[94:95], v[94:95], v[156:157], v[134:135] op_sel_hi:[1,0,1]
  v_pk_mul_f32 v[128:129], v[88:89], v[88:89]
  v_pk_mul_f32 v[132:133], v[92:93], v[92:93]
  v_pk_mul_f32 v[130:131], v[90:91], v[90:91]
  v_pk_mul_f32 v[134:135], v[94:95], v[94:95]
  v_pk_fma_f32 v[128:129], v[128:129], s[44:45], v[12:13]
  v_pk_fma_f32 v[132:133], v[132:133], s[44:45], v[12:13]
  v_pk_fma_f32 v[130:131], v[130:131], s[44:45], v[12:13]
  v_pk_fma_f32 v[134:135], v[134:135], s[44:45], v[12:13]
  v_pk_mul_f32 v[128:129], v[128:129], v[88:89]
  v_pk_mul_f32 v[132:133], v[132:133], v[92:93]
  v_pk_mul_f32 v[130:131], v[130:131], v[90:91]
  v_pk_mul_f32 v[134:135], v[134:135], v[94:95]
  v_exp_f32 v128, v128
  v_exp_f32 v132, v132
  v_exp_f32 v129, v129
  v_exp_f32 v133, v133
  v_exp_f32 v130, v130
  v_exp_f32 v134, v134
  v_exp_f32 v131, v131
  v_exp_f32 v135, v135
  v_pk_add_f32 v[128:129], v[128:129], 1.0 op_sel_hi:[1,0]
  v_pk_add_f32 v[132:133], v[132:133], 1.0 op_sel_hi:[1,0]
  v_pk_add_f32 v[130:131], v[130:131], 1.0 op_sel_hi:[1,0]
  v_pk_add_f32 v[134:135], v[134:135], 1.0 op_sel_hi:[1,0]
  v_rcp_f32 v128, v128
  v_rcp_f32 v132, v132
  v_rcp_f32 v129, v129
  v_rcp_f32 v133, v133
  v_rcp_f32 v130, v130
  v_rcp_f32 v134, v134
  v_rcp_f32 v131, v131
  v_rcp_f32 v135, v135
  v_pk_mul_f32 v[88:89], v[88:89], v[128:129]
  v_pk_mul_f32 v[92:93], v[92:93], v[132:133]
  v_pk_mul_f32 v[90:91], v[90:91], v[130:131]
  v_pk_mul_f32 v[94:95], v[94:95], v[134:135]
  v_cvt_pk_bf16_f32 v144, v88, v89
  v_cvt_pk_bf16_f32 v145, v90, v91
  v_cvt_pk_bf16_f32 v146, v92, v93
  v_cvt_pk_bf16_f32 v147, v94, v95
  buffer_store_dwordx4 v[144:147], v9, s[28:31], s50 offen offset:2048 sc1
  v_pk_fma_f32 v[128:129], v[188:189], v[158:159], v[160:161] op_sel:[0,1,0] op_sel_hi:[1,1,1]
  v_pk_fma_f32 v[132:133], v[192:193], v[158:159], v[164:165] op_sel:[0,1,0] op_sel_hi:[1,1,1]
  v_pk_fma_f32 v[130:131], v[190:191], v[158:159], v[162:163] op_sel:[0,1,0] op_sel_hi:[1,1,1]
  v_pk_fma_f32 v[134:135], v[194:195], v[158:159], v[166:167] op_sel:[0,1,0] op_sel_hi:[1,1,1]
  v_pk_fma_f32 v[100:101], v[100:101], v[158:159], v[128:129] op_sel_hi:[1,0,1]
  v_pk_fma_f32 v[104:105], v[104:105], v[158:159], v[132:133] op_sel_hi:[1,0,1]
  v_pk_fma_f32 v[102:103], v[102:103], v[158:159], v[130:131] op_sel_hi:[1,0,1]
  v_pk_fma_f32 v[106:107], v[106:107], v[158:159], v[134:135] op_sel_hi:[1,0,1]
  v_pk_mul_f32 v[128:129], v[100:101], v[100:101]
  v_pk_mul_f32 v[132:133], v[104:105], v[104:105]
  v_pk_mul_f32 v[130:131], v[102:103], v[102:103]
  v_pk_mul_f32 v[134:135], v[106:107], v[106:107]
  v_pk_fma_f32 v[128:129], v[128:129], s[44:45], v[12:13]
  v_pk_fma_f32 v[132:133], v[132:133], s[44:45], v[12:13]
  v_pk_fma_f32 v[130:131], v[130:131], s[44:45], v[12:13]
  v_pk_fma_f32 v[134:135], v[134:135], s[44:45], v[12:13]
  v_pk_mul_f32 v[128:129], v[128:129], v[100:101]
  v_pk_mul_f32 v[132:133], v[132:133], v[104:105]
  v_pk_mul_f32 v[130:131], v[130:131], v[102:103]
  v_pk_mul_f32 v[134:135], v[134:135], v[106:107]
  v_exp_f32 v128, v128
  v_exp_f32 v132, v132
  v_exp_f32 v129, v129
  v_exp_f32 v133, v133
  v_exp_f32 v130, v130
  v_exp_f32 v134, v134
  v_exp_f32 v131, v131
  v_exp_f32 v135, v135
  v_pk_add_f32 v[128:129], v[128:129], 1.0 op_sel_hi:[1,0]
  v_pk_add_f32 v[132:133], v[132:133], 1.0 op_sel_hi:[1,0]
  v_pk_add_f32 v[130:131], v[130:131], 1.0 op_sel_hi:[1,0]
  v_pk_add_f32 v[134:135], v[134:135], 1.0 op_sel_hi:[1,0]
  v_rcp_f32 v128, v128
  v_rcp_f32 v132, v132
  v_rcp_f32 v129, v129
  v_rcp_f32 v133, v133
  v_rcp_f32 v130, v130
  v_rcp_f32 v134, v134
  v_rcp_f32 v131, v131
  v_rcp_f32 v135, v135
  v_pk_mul_f32 v[100:101], v[100:101], v[128:129]
  v_pk_mul_f32 v[104:105], v[104:105], v[132:133]
  v_pk_mul_f32 v[102:103], v[102:103], v[130:131]
  v_pk_mul_f32 v[106:107], v[106:107], v[134:135]
  v_cvt_pk_bf16_f32 v148, v100, v101
  v_cvt_pk_bf16_f32 v149, v102, v103
  v_cvt_pk_bf16_f32 v150, v104, v105
  v_cvt_pk_bf16_f32 v151, v106, v107
  buffer_store_dwordx4 v[148:151], v9, s[28:31], s51 offen offset:0 sc1
  v_pk_fma_f32 v[128:129], v[196:197], v[158:159], v[168:169] op_sel:[0,1,0] op_sel_hi:[1,1,1]
  v_pk_fma_f32 v[132:133], v[200:201], v[158:159], v[172:173] op_sel:[0,1,0] op_sel_hi:[1,1,1]
  v_pk_fma_f32 v[130:131], v[198:199], v[158:159], v[170:171] op_sel:[0,1,0] op_sel_hi:[1,1,1]
  v_pk_fma_f32 v[134:135], v[202:203], v[158:159], v[174:175] op_sel:[0,1,0] op_sel_hi:[1,1,1]
  v_pk_fma_f32 v[108:109], v[108:109], v[158:159], v[128:129] op_sel_hi:[1,0,1]
  v_pk_fma_f32 v[112:113], v[112:113], v[158:159], v[132:133] op_sel_hi:[1,0,1]
  v_pk_fma_f32 v[110:111], v[110:111], v[158:159], v[130:131] op_sel_hi:[1,0,1]
  v_pk_fma_f32 v[114:115], v[114:115], v[158:159], v[134:135] op_sel_hi:[1,0,1]
  v_pk_mul_f32 v[128:129], v[108:109], v[108:109]
  v_pk_mul_f32 v[132:133], v[112:113], v[112:113]
  v_pk_mul_f32 v[130:131], v[110:111], v[110:111]
  v_pk_mul_f32 v[134:135], v[114:115], v[114:115]
  v_pk_fma_f32 v[128:129], v[128:129], s[44:45], v[12:13]
  v_pk_fma_f32 v[132:133], v[132:133], s[44:45], v[12:13]
  v_pk_fma_f32 v[130:131], v[130:131], s[44:45], v[12:13]
  v_pk_fma_f32 v[134:135], v[134:135], s[44:45], v[12:13]
  v_pk_mul_f32 v[128:129], v[128:129], v[108:109]
  v_pk_mul_f32 v[132:133], v[132:133], v[112:113]
  v_pk_mul_f32 v[130:131], v[130:131], v[110:111]
  v_pk_mul_f32 v[134:135], v[134:135], v[114:115]
  v_exp_f32 v128, v128
  v_exp_f32 v132, v132
  v_exp_f32 v129, v129
  v_exp_f32 v133, v133
  v_exp_f32 v130, v130
  v_exp_f32 v134, v134
  v_exp_f32 v131, v131
  v_exp_f32 v135, v135
  v_pk_add_f32 v[128:129], v[128:129], 1.0 op_sel_hi:[1,0]
  v_pk_add_f32 v[132:133], v[132:133], 1.0 op_sel_hi:[1,0]
  v_pk_add_f32 v[130:131], v[130:131], 1.0 op_sel_hi:[1,0]
  v_pk_add_f32 v[134:135], v[134:135], 1.0 op_sel_hi:[1,0]
  v_rcp_f32 v128, v128
  v_rcp_f32 v132, v132
  v_rcp_f32 v129, v129
  v_rcp_f32 v133, v133
  v_rcp_f32 v130, v130
  v_rcp_f32 v134, v134
  v_rcp_f32 v131, v131
  v_rcp_f32 v135, v135
  v_pk_mul_f32 v[108:109], v[108:109], v[128:129]
  v_pk_mul_f32 v[112:113], v[112:113], v[132:133]
  v_pk_mul_f32 v[110:111], v[110:111], v[130:131]
  v_pk_mul_f32 v[114:115], v[114:115], v[134:135]
  v_cvt_pk_bf16_f32 v136, v108, v109
  v_cvt_pk_bf16_f32 v137, v110, v111
  v_cvt_pk_bf16_f32 v138, v112, v113
  v_cvt_pk_bf16_f32 v139, v114, v115
  buffer_store_dwordx4 v[136:139], v9, s[28:31], s51 offen offset:1024 sc1
  v_pk_fma_f32 v[128:129], v[204:205], v[158:159], v[176:177] op_sel:[0,1,0] op_sel_hi:[1,1,1]
  v_pk_fma_f32 v[132:133], v[208:209], v[158:159], v[180:181] op_sel:[0,1,0] op_sel_hi:[1,1,1]
  v_pk_fma_f32 v[130:131], v[206:207], v[158:159], v[178:179] op_sel:[0,1,0] op_sel_hi:[1,1,1]
  v_pk_fma_f32 v[134:135], v[210:211], v[158:159], v[182:183] op_sel:[0,1,0] op_sel_hi:[1,1,1]
  v_pk_fma_f32 v[116:117], v[116:117], v[158:159], v[128:129] op_sel_hi:[1,0,1]
  v_pk_fma_f32 v[120:121], v[120:121], v[158:159], v[132:133] op_sel_hi:[1,0,1]
  v_pk_fma_f32 v[118:119], v[118:119], v[158:159], v[130:131] op_sel_hi:[1,0,1]
  v_pk_fma_f32 v[122:123], v[122:123], v[158:159], v[134:135] op_sel_hi:[1,0,1]
  v_pk_mul_f32 v[128:129], v[116:117], v[116:117]
  v_pk_mul_f32 v[132:133], v[120:121], v[120:121]
  v_pk_mul_f32 v[130:131], v[118:119], v[118:119]
  v_pk_mul_f32 v[134:135], v[122:123], v[122:123]
  v_pk_fma_f32 v[128:129], v[128:129], s[44:45], v[12:13]
  v_pk_fma_f32 v[132:133], v[132:133], s[44:45], v[12:13]
  v_pk_fma_f32 v[130:131], v[130:131], s[44:45], v[12:13]
  v_pk_fma_f32 v[134:135], v[134:135], s[44:45], v[12:13]
  v_pk_mul_f32 v[128:129], v[128:129], v[116:117]
  v_pk_mul_f32 v[132:133], v[132:133], v[120:121]
  v_pk_mul_f32 v[130:131], v[130:131], v[118:119]
  v_pk_mul_f32 v[134:135], v[134:135], v[122:123]
  v_exp_f32 v128, v128
  v_exp_f32 v132, v132
  v_exp_f32 v129, v129
  v_exp_f32 v133, v133
  v_exp_f32 v130, v130
  v_exp_f32 v134, v134
  v_exp_f32 v131, v131
  v_exp_f32 v135, v135
  v_pk_add_f32 v[128:129], v[128:129], 1.0 op_sel_hi:[1,0]
  v_pk_add_f32 v[132:133], v[132:133], 1.0 op_sel_hi:[1,0]
  v_pk_add_f32 v[130:131], v[130:131], 1.0 op_sel_hi:[1,0]
  v_pk_add_f32 v[134:135], v[134:135], 1.0 op_sel_hi:[1,0]
  v_rcp_f32 v128, v128
  v_rcp_f32 v132, v132
  v_rcp_f32 v129, v129
  v_rcp_f32 v133, v133
  v_rcp_f32 v130, v130
  v_rcp_f32 v134, v134
  v_rcp_f32 v131, v131
  v_rcp_f32 v135, v135
  v_pk_mul_f32 v[116:117], v[116:117], v[128:129]
  v_pk_mul_f32 v[120:121], v[120:121], v[132:133]
  v_pk_mul_f32 v[118:119], v[118:119], v[130:131]
  v_pk_mul_f32 v[122:123], v[122:123], v[134:135]
  v_cvt_pk_bf16_f32 v140, v116, v117
  v_cvt_pk_bf16_f32 v141, v118, v119
  v_cvt_pk_bf16_f32 v142, v120, v121
  v_cvt_pk_bf16_f32 v143, v122, v123
  buffer_store_dwordx4 v[140:143], v9, s[28:31], s51 offen offset:2048 sc1
ffn1_done:
  s_lshl_b32 s24, s9, 11
  s_lshl_b32 s25, s10, 7
  s_add_u32 s24, s24, s25
  s_add_u32 s42, s24, 98304
  s_mov_b64 exec, -1
ffn2:
  s_mov_b32 s8, s62
  s_bfe_u32 s43, s2, 65538
  s_bfe_u32 s24, s2, 65536
  s_lshl_b32 s24, s24, 3
  s_bfe_u32 s9, s2, 0x30003
  s_add_u32 s9, s9, s24
  s_bfe_u32 s24, s2, 65537
  s_lshl_b32 s24, s24, 2
  s_lshr_b32 s10, s2, 6
  s_add_u32 s10, s10, s24
  s_cmp_lt_u32 s8, 4
  s_cbranch_scc1 ffn2_comp
  s_sub_u32 s8, s8, 4
  s_xor_b32 s25, s8, s43
  s_lshl_b32 s24, s9, 3
  s_lshl_b32 s25, s25, 1
  s_add_u32 s24, s24, s25
  s_mul_i32 s24, s24, 114688
  v_lshl_add_u32 v2, v0, 4, s24
  v_add_u32 v3, 114688, v2
  s_mul_i32 s21, s10, 917504
  s_mov_b32 s20, 0
  s_mul_i32 s24, s8, 4096
  v_lshl_add_u32 v4, v0, 4, s24
  v_add_u32 v5, 4096, v4
  s_mul_i32 s20, s43, 57344
  s_lshl_b32 s24, s20, 2
  s_add_u32 s21, s21, s24
  s_and_b32 s24, s8, 1
  s_mul_i32 s24, s24, 458752
  s_lshr_b32 s25, s8, 1
  s_lshl_b32 s25, s25, 12
  s_add_u32 s24, s24, s25
  v_lshl_add_u32 v4, v0, 4, s24
  s_mul_i32 s44, s8, 4096
  s_mul_i32 s45, s8, 4096
  s_add_u32 s45, s45, 16384
  s_add_u32 s12, s4, 0x1800000
  s_addc_u32 s13, s5, 0
  s_mov_b32 s14, 0xe00000
  s_mov_b32 s15, 0x20000
  s_add_u32 s16, s4, 0x4000000
  s_addc_u32 s17, s5, 0
  s_mov_b32 s18, 0x700000
  s_mov_b32 s19, 0x20000
  s_add_u32 s36, s4, 0x2a00000
  s_addc_u32 s37, s5, 0
  s_mov_b32 s38, 0x40000
  s_mov_b32 s39, 0x20000
  s_add_u32 m0, s45, 0
  s_nop 0
  buffer_load_dwordx4 v4, s[16:19], s21 offen offset:0 sc1 lds
  buffer_load_dwordx4 v4, s[16:19], s21 offen offset:1024 sc1 lds
  buffer_load_dwordx4 v4, s[16:19], s21 offen offset:2048 sc1 lds
  buffer_load_dwordx4 v4, s[16:19], s21 offen offset:3072 sc1 lds
  s_add_u32 s21, s21, 8192
  s_add_u32 m0, s45, 32768
  s_nop 0
  buffer_load_dwordx4 v4, s[16:19], s21 offen offset:0 sc1 lds
  buffer_load_dwordx4 v4, s[16:19], s21 offen offset:1024 sc1 lds
  buffer_load_dwordx4 v4, s[16:19], s21 offen offset:2048 sc1 lds
  buffer_load_dwordx4 v4, s[16:19], s21 offen offset:3072 sc1 lds
  s_add_u32 s21, s21, 8192
  s_add_u32 m0, s45, 65536
  s_nop 0
  buffer_load_dwordx4 v4, s[16:19], s21 offen offset:0 sc1 lds
  buffer_load_dwordx4 v4, s[16:19], s21 offen offset:1024 sc1 lds
  buffer_load_dwordx4 v4, s[16:19], s21 offen offset:2048 sc1 lds
  buffer_load_dwordx4 v4, s[16:19], s21 offen offset:3072 sc1 lds
  s_add_u32 s21, s21, 8192
  s_add_u32 m0, s45, 98304
  s_nop 0
  buffer_load_dwordx4 v4, s[16:19], s21 offen offset:0 sc1 lds
  buffer_load_dwordx4 v4, s[16:19], s21 offen offset:1024 sc1 lds
  buffer_load_dwordx4 v4, s[16:19], s21 offen offset:2048 sc1 lds
  buffer_load_dwordx4 v4, s[16:19], s21 offen offset:3072 sc1 lds
  s_add_u32 s21, s21, 8192
  s_barrier
  s_barrier
  s_add_u32 m0, s44, 0
  s_nop 0
  buffer_load_dwordx4 v2, s[12:15], s20 offen offset:0 sc1 lds
  buffer_load_dwordx4 v2, s[12:15], s20 offen offset:1024 sc1 lds
  s_add_u32 m0, s44, 2048
  s_nop 0
  buffer_load_dwordx4 v3, s[12:15], s20 offen offset:0 sc1 lds
  buffer_load_dwordx4 v3, s[12:15], s20 offen offset:1024 sc1 lds
  s_add_u32 s20, s20, 2048
  s_add_u32 m0, s44, 32768
  s_nop 0
  buffer_load_dwordx4 v2, s[12:15], s20 offen offset:0 sc1 lds
  buffer_load_dwordx4 v2, s[12:15], s20 offen offset:1024 sc1 lds
  s_add_u32 m0, s44, 34816
  s_nop 0
  buffer_load_dwordx4 v3, s[12:15], s20 offen offset:0 sc1 lds
  buffer_load_dwordx4 v3, s[12:15], s20 offen offset:1024 sc1 lds
  s_add_u32 s20, s20, 2048
  s_waitcnt vmcnt(4)
  s_barrier
  s_add_u32 m0, s44, 65536
  s_nop 0
  buffer_load_dwordx4 v2, s[12:15], s20 offen offset:0 sc1 lds
  buffer_load_dwordx4 v2, s[12:15], s20 offen offset:1024 sc1 lds
  s_add_u32 m0, s44, 67584
  s_nop 0
  buffer_load_dwordx4 v3, s[12:15], s20 offen offset:0 sc1 lds
  buffer_load_dwordx4 v3, s[12:15], s20 offen offset:1024 sc1 lds
  s_add_u32 s20, s20, 2048
  s_add_u32 m0, s44, 98304
  s_nop 0
  buffer_load_dwordx4 v2, s[12:15], s20 offen offset:0 sc1 lds
  buffer_load_dwordx4 v2, s[12:15], s20 offen offset:1024 sc1 lds
  s_add_u32 m0, s44, 100352
  s_nop 0
  buffer_load_dwordx4 v3, s[12:15], s20 offen offset:0 sc1 lds
  buffer_load_dwordx4 v3, s[12:15], s20 offen offset:1024 sc1 lds
  s_add_u32 s20, s20, 2048
  s_waitcnt vmcnt(8)
  s_barrier
  s_add_u32 m0, s45, 0
  s_nop 0
  buffer_load_dwordx4 v4, s[16:19], s21 offen offset:0 sc1 lds
  buffer_load_dwordx4 v4, s[16:19], s21 offen offset:1024 sc1 lds
  buffer_load_dwordx4 v4, s[16:19], s21 offen offset:2048 sc1 lds
  buffer_load_dwordx4 v4, s[16:19], s21 offen offset:3072 sc1 lds
  s_add_u32 s21, s21, 8192
  s_add_u32 m0, s44, 0
  s_nop 0
  buffer_load_dwordx4 v2, s[12:15], s20 offen offset:0 sc1 lds
  buffer_load_dwordx4 v2, s[12:15], s20 offen offset:1024 sc1 lds
  s_add_u32 m0, s44, 2048
  s_nop 0
  buffer_load_dwordx4 v3, s[12:15], s20 offen offset:0 sc1 lds
  buffer_load_dwordx4 v3, s[12:15], s20 offen offset:1024 sc1 lds
  s_add_u32 s20, s20, 2048
  s_waitcnt vmcnt(12)
  s_barrier
  s_mov_b32 s22, 32768
  s_mov_b32 s23, 5
ffn2_ld:
  s_add_u32 s46, s22, s44
  s_add_u32 s47, s22, s45
  s_add_u32 m0, s47, 0
  s_nop 0
  buffer_load_dwordx4 v4, s[16:19], s21 offen offset:0 sc1 lds
  buffer_load_dwordx4 v4, s[16:19], s21 offen offset:1024 sc1 lds
  buffer_load_dwordx4 v4, s[16:19], s21 offen offset:2048 sc1 lds
  buffer_load_dwordx4 v4, s[16:19], s21 offen offset:3072 sc1 lds
  s_add_u32 s21, s21, 8192
  s_add_u32 m0, s46, 0
  s_nop 0
  buffer_load_dwordx4 v2, s[12:15], s20 offen offset:0 sc1 lds
  buffer_load_dwordx4 v2, s[12:15], s20 offen offset:1024 sc1 lds
  s_add_u32 m0, s46, 2048
  s_nop 0
  buffer_load_dwordx4 v3, s[12:15], s20 offen offset:0 sc1 lds
  buffer_load_dwordx4 v3, s[12:15], s20 offen offset:1024 sc1 lds
  s_add_u32 s20, s20, 2048
  s_add_u32 s22, s22, 32768
  s_cmp_eq_u32 s22, 131072
  s_cselect_b32 s22, 0, s22
  s_add_u32 s23, s23, 1
  s_cmp_lt_u32 s23, 4
  s_cbranch_scc1 ffn2_ld
  s_waitcnt vmcnt(16)
  s_barrier
  s_cmp_lt_u32 s23, 24
  s_cbranch_scc1 ffn2_ld
  s_add_u32 s52, s4, 0x4800000
  s_addc_u32 s53, s5, 0
  s_mov_b32 s54, 0x800000
  s_mov_b32 s55, 0x20000
  s_lshr_b32 s24, s8, 1
  s_lshl_b32 s24, s24, 2
  s_and_b32 s25, s8, 1
  s_add_u32 s24, s24, s25
  s_lshl_b32 s44, s24, 11
  s_lshl_b32 s25, s43, 1
  s_add_u32 s24, s24, s25
  s_lshl_b32 s25, s9, 3
  s_add_u32 s24, s24, s25
  s_mul_i32 s24, s24, 114688
  v_lshl_add_u32 v2, v0, 4, s24
  s_lshl_b32 s24, s2, 2
  s_add_u32 s24, s24, s8
  s_xor_b32 s24, s24, 16
  s_lshl_b32 s58, s24, 12
  s_lshl_b32 s41, s24, 6
  s_add_u32 s41, s41, 163840
  s_lshl_b32 s46, s8, 13
  s_add_u32 s46, s46, 131072
  v_lshlrev_b32 v6, 4, v0
  v_mov_b32 v7, 0
  s_add_u32 m0, s45, 0
  s_nop 0
  buffer_load_dwordx4 v4, s[16:19], s21 offen offset:0 sc1 lds
  buffer_load_dwordx4 v4, s[16:19], s21 offen offset:1024 sc1 lds
  buffer_load_dwordx4 v4, s[16:19], s21 offen offset:2048 sc1 lds
  buffer_load_dwordx4 v4, s[16:19], s21 offen offset:3072 sc1 lds
  s_add_u32 s21, s21, 8192
  s_add_u32 m0, s44, 0
  s_nop 0
  buffer_load_dwordx4 v2, s[12:15], s20 offen offset:0 sc1 lds
  buffer_load_dwordx4 v2, s[12:15], s20 offen offset:1024 sc1 lds
  s_add_u32 s20, s20, 2048
  s_waitcnt vmcnt(14)
  s_barrier
  s_add_u32 m0, s45, 32768
  s_nop 0
  buffer_load_dwordx4 v4, s[16:19], s21 offen offset:0 sc1 lds
  buffer_load_dwordx4 v4, s[16:19], s21 offen offset:1024 sc1 lds
  buffer_load_dwordx4 v4, s[16:19], s21 offen offset:2048 sc1 lds
  buffer_load_dwordx4 v4, s[16:19], s21 offen offset:3072 sc1 lds
  s_add_u32 s21, s21, 8192
  s_add_u32 m0, s44, 32768
  s_nop 0
  buffer_load_dwordx4 v2, s[12:15], s20 offen offset:0 sc1 lds
  buffer_load_dwordx4 v2, s[12:15], s20 offen offset:1024 sc1 lds
  s_add_u32 s20, s20, 2048
  s_waitcnt vmcnt(12)
  s_barrier
  s_add_u32 m0, s45, 65536
  s_nop 0
  buffer_load_dwordx4 v4, s[16:19], s21 offen offset:0 sc1 lds
  buffer_load_dwordx4 v4, s[16:19], s21 offen offset:1024 sc1 lds
  buffer_load_dwordx4 v4, s[16:19], s21 offen offset:2048 sc1 lds
  buffer_load_dwordx4 v4, s[16:19], s21 offen offset:3072 sc1 lds
  s_add_u32 s21, s21, 8192
  s_add_u32 m0, s44, 65536
  s_nop 0
  buffer_load_dwordx4 v2, s[12:15], s20 offen offset:0 sc1 lds
  buffer_load_dwordx4 v2, s[12:15], s20 offen offset:1024 sc1 lds
  s_add_u32 s20, s20, 2048
  s_waitcnt vmcnt(12)
  s_barrier
  s_add_u32 m0, s45, 98304
  s_nop 0
  buffer_load_dwordx4 v4, s[16:19], s21 offen offset:0 sc1 lds
  buffer_load_dwordx4 v4, s[16:19], s21 offen offset:1024 sc1 lds
  buffer_load_dwordx4 v4, s[16:19], s21 offen offset:2048 sc1 lds
  buffer_load_dwordx4 v4, s[16:19], s21 offen offset:3072 sc1 lds
  s_add_u32 s21, s21, 8192
  s_add_u32 m0, s44, 98304
  s_nop 0
  buffer_load_dwordx4 v2, s[12:15], s20 offen offset:0 sc1 lds
  buffer_load_dwordx4 v2, s[12:15], s20 offen offset:1024 sc1 lds
  s_add_u32 s20, s20, 2048
  s_waitcnt vmcnt(12)
  s_barrier
  s_cmp_eq_u32 s43, 0
  s_cselect_b32 s24, 48, -64
  s_lshl_b32 s25, s24, 10
  s_add_u32 s20, s20, s25
  s_lshl_b32 s25, s24, 12
  s_add_u32 s21, s21, s25
  s_add_u32 m0, s45, 0
  s_nop 0
  buffer_load_dwordx4 v4, s[16:19], s21 offen offset:0 sc1 lds
  buffer_load_dwordx4 v4, s[16:19], s21 offen offset:1024 sc1 lds
  buffer_load_dwordx4 v4, s[16:19], s21 offen offset:2048 sc1 lds
  buffer_load_dwordx4 v4, s[16:19], s21 offen offset:3072 sc1 lds
  s_add_u32 s21, s21, 8192
  s_add_u32 m0, s44, 0
  s_nop 0
  buffer_load_dwordx4 v2, s[12:15], s20 offen offset:0 sc1 lds
  buffer_load_dwordx4 v2, s[12:15], s20 offen offset:1024 sc1 lds
  s_add_u32 s20, s20, 2048
  s_waitcnt vmcnt(12)
  s_barrier
  s_add_u32 m0, s45, 32768
  s_nop 0
  buffer_load_dwordx4 v4, s[16:19], s21 offen offset:0 sc1 lds
  buffer_load_dwordx4 v4, s[16:19], s21 offen offset:1024 sc1 lds
  buffer_load_dwordx4 v4, s[16:19], s21 offen offset:2048 sc1 lds
  buffer_load_dwordx4 v4, s[16:19], s21 offen offset:3072 sc1 lds
  s_add_u32 s21, s21, 8192
  s_add_u32 m0, s44, 32768
  s_nop 0
  buffer_load_dwordx4 v2, s[12:15], s20 offen offset:0 sc1 lds
  buffer_load_dwordx4 v2, s[12:15], s20 offen offset:1024 sc1 lds
  s_add_u32 s20, s20, 2048
  s_waitcnt vmcnt(12)
  s_barrier
  s_add_u32 m0, s45, 65536
  s_nop 0
  buffer_load_dwordx4 v4, s[16:19], s21 offen offset:0 sc1 lds
  buffer_load_dwordx4 v4, s[16:19], s21 offen offset:1024 sc1 lds
  buffer_load_dwordx4 v4, s[16:19], s21 offen offset:2048 sc1 lds
  buffer_load_dwordx4 v4, s[16:19], s21 offen offset:3072 sc1 lds
  s_add_u32 s21, s21, 8192
  s_add_u32 m0, s44, 65536
  s_nop 0
  buffer_load_dwordx4 v2, s[12:15], s20 offen offset:0 sc1 lds
  buffer_load_dwordx4 v2, s[12:15], s20 offen offset:1024 sc1 lds
  s_add_u32 s20, s20, 2048
  s_waitcnt vmcnt(12)
  s_barrier
  buffer_load_dword v16, v7, s[36:39], s41 offen sc1
  s_add_u32 m0, s45, 98304
  s_nop 0
  buffer_load_dwordx4 v4, s[16:19], s21 offen offset:0 sc1 lds
  buffer_load_dwordx4 v4, s[16:19], s21 offen offset:1024 sc1 lds
  buffer_load_dwordx4 v4, s[16:19], s21 offen offset:2048 sc1 lds
  buffer_load_dwordx4 v4, s[16:19], s21 offen offset:3072 sc1 lds
  s_add_u32 s21, s21, 8192
  s_add_u32 m0, s44, 98304
  s_nop 0
  buffer_load_dwordx4 v2, s[12:15], s20 offen offset:0 sc1 lds
  buffer_load_dwordx4 v2, s[12:15], s20 offen offset:1024 sc1 lds
  s_add_u32 s20, s20, 2048
  s_waitcnt vmcnt(13)
  s_barrier
  s_waitcnt vmcnt(6)
  v_cmp_eq_u32 vcc, 0, v16
  s_nop 4
  s_cbranch_vccz ffn2_xr
  v_and_b32 v8, 0, v0
  v_lshlrev_b32 v8, 7, v8
  s_mov_b32 s63, 0x40000
poll14:
  buffer_load_dword v12, v8, s[36:39], s41 offen sc1
  s_sub_u32 s63, s63, 1
  s_waitcnt vmcnt(0)
  v_cmp_eq_u32 vcc, 0, v12
  s_nop 3
  s_cbranch_scc1 poll14x
  s_cbranch_vccz poll14x
  s_sleep 2
  s_branch poll14
poll14x:
ffn2_xr:
  s_add_u32 m0, s46, 0
  s_nop 0
  buffer_load_dwordx4 v6, s[52:55], s58 offen offset:0 sc1 lds
  buffer_load_dwordx4 v6, s[52:55], s58 offen offset:1024 sc1 lds
  buffer_load_dwordx4 v6, s[52:55], s58 offen offset:2048 sc1 lds
  buffer_load_dwordx4 v6, s[52:55], s58 offen offset:3072 sc1 lds
  s_barrier
  s_waitcnt vmcnt(4)
  s_barrier
  s_waitcnt vmcnt(0)
  s_barrier
  s_endpgm
ffn2_comp:
  s_lshr_b32 s11, s8, 1
  s_and_b32 s3, s8, 1
  v_and_b32 v1, 15, v0
  v_lshrrev_b32 v2, 4, v0
  s_mul_i32 s24, s11, 8192
  v_lshl_add_u32 v3, v0, 4, s24
  s_mul_i32 s24, s3, 4096
  s_add_u32 s24, s24, 16384
  v_lshl_add_u32 v4, v0, 4, s24
  v_mov_b32 v6, v3
  v_mov_b32 v7, v4
  s_lshl_b32 s27, s9, 3
  s_mul_i32 s24, s11, 4
  s_add_u32 s27, s27, s24
  s_lshl_b32 s24, s43, 1
  s_add_u32 s27, s27, s24
  s_lshl_b32 s10, s10, 1
  s_add_u32 s10, s10, s3
  v_mov_b32 v16, 0
  v_mov_b32 v17, 0
  v_mov_b32 v18, 0
  v_mov_b32 v19, 0
  v_mov_b32 v20, 0
  v_mov_b32 v21, 0
  v_mov_b32 v22, 0
  v_mov_b32 v23, 0
  v_mov_b32 v24, 0
  v_mov_b32 v25, 0
  v_mov_b32 v26, 0
  v_mov_b32 v27, 0
  v_mov_b32 v28, 0
  v_mov_b32 v29, 0
  v_mov_b32 v30, 0
  v_mov_b32 v31, 0
  v_mov_b32 v32, 0
  v_mov_b32 v33, 0
  v_mov_b32 v34, 0
  v_mov_b32 v35, 0
  v_mov_b32 v36, 0
  v_mov_b32 v37, 0
  v_mov_b32 v38, 0
  v_mov_b32 v39, 0
  v_mov_b32 v40, 0
  v_mov_b32 v41, 0
  v_mov_b32 v42, 0
  v_mov_b32 v43, 0
  v_mov_b32 v44, 0
  v_mov_b32 v45, 0
  v_mov_b32 v46, 0
  v_mov_b32 v47, 0
  v_mov_b32 v48, 0
  v_mov_b32 v49, 0
  v_mov_b32 v50, 0
  v_mov_b32 v51, 0
  v_mov_b32 v52, 0
  v_mov_b32 v53, 0
  v_mov_b32 v54, 0
  v_mov_b32 v55, 0
  v_mov_b32 v56, 0
  v_mov_b32 v57, 0
  v_mov_b32 v58, 0
  v_mov_b32 v59, 0
  v_mov_b32 v60, 0
  v_mov_b32 v61, 0
  v_mov_b32 v62, 0
  v_mov_b32 v63, 0
  v_mov_b32 v64, 0
  v_mov_b32 v65, 0
  v_mov_b32 v66, 0
  v_mov_b32 v67, 0
  v_mov_b32 v68, 0
  v_mov_b32 v69, 0
  v_mov_b32 v70, 0
  v_mov_b32 v71, 0
  v_mov_b32 v72, 0
  v_mov_b32 v73, 0
  v_mov_b32 v74, 0
  v_mov_b32 v75, 0
  v_mov_b32 v76, 0
  v_mov_b32 v77, 0
  v_mov_b32 v78, 0
  v_mov_b32 v79, 0
  s_add_u32 s28, s4, 0x1400000
  s_addc_u32 s29, s5, 0
  s_mov_b32 s30, 0x400000
  s_mov_b32 s31, 0x20000
  s_mov_b32 s32, s98
  s_mov_b32 s33, s99
  s_mov_b32 s34, 0x800
  s_mov_b32 s35, 0x20000
  s_mov_b32 s48, s100
  s_mov_b32 s49, s101
  s_mov_b32 s50, 0x400000
  s_mov_b32 s51, 0x20000
  s_add_u32 s52, s4, 0x4800000
  s_addc_u32 s53, s5, 0
  s_mov_b32 s54, 0x800000
  s_mov_b32 s55, 0x20000
  s_lshl_b32 s24, s27, 15
  s_lshl_b32 s25, s10, 11
  s_add_u32 s24, s24, s25
  s_add_u32 s25, s24, 32768
  v_lshlrev_b32 v9, 4, v0
  s_lshl_b32 s26, s10, 7
  v_lshlrev_b32 v10, 3, v2
  s_lshl_b32 s60, s9, 11
  s_add_u32 s60, s60, 98304
  s_waitcnt vmcnt(0)
  s_add_u32 s36, s4, 0x2a00000
  s_addc_u32 s37, s5, 0
  s_mov_b32 s38, 0x40000
  s_mov_b32 s39, 0x20000
  s_barrier
  s_cmp_eq_u32 s62, 0
  s_cbranch_scc0 ho15a
  v_mov_b32 v82, 0
  v_mov_b32 v83, 1
  s_mov_b64 exec, 1
  buffer_store_dword v83, v82, s[36:39], s42 offen sc1
  s_mov_b64 exec, -1
ho15a:
  s_cmp_eq_u32 s62, 1
  s_cbranch_scc0 ho15
  v_and_b32 v80, 15, v0
  v_lshlrev_b32 v80, 7, v80
  s_mov_b32 s63, 0x40000
poll16:
  buffer_load_dword v84, v80, s[36:39], s60 offen sc1
  s_sub_u32 s63, s63, 1
  s_waitcnt vmcnt(0)
  v_cmp_eq_u32 vcc, 0, v84
  s_nop 3
  s_cbranch_scc1 poll16x
  s_cbranch_vccz poll16x
  s_sleep 2
  s_branch poll16
poll16x:
ho15:
  s_barrier
  s_mov_b32 s22, 0
  s_mov_b32 s23, 24
  s_barrier
  ds_read_b128 v[96:99], v7 offset:0
  ds_read_b128 v[80:83], v6 offset:0
  ds_read_b128 v[84:87], v6 offset:2048
  ds_read_b128 v[88:91], v6 offset:4096
  ds_read_b128 v[92:95], v6 offset:6144
  ds_read_b128 v[100:103], v7 offset:1024
  ds_read_b128 v[104:107], v7 offset:2048
  ds_read_b128 v[108:111], v7 offset:3072
  buffer_load_dwordx4 v[144:147], v9, s[28:31], s24 offen offset:0 sc1
  buffer_load_dwordx4 v[148:151], v9, s[28:31], s24 offen offset:1024 sc1
  buffer_load_dwordx4 v[152:155], v9, s[28:31], s25 offen offset:0 sc1
  buffer_load_dwordx4 v[156:159], v9, s[28:31], s25 offen offset:1024 sc1
  buffer_load_dwordx2 v[160:161], v10, s[32:35], s26 offen offset:0 sc1
  buffer_load_dwordx2 v[162:163], v10, s[32:35], s26 offen offset:32 sc1
  buffer_load_dwordx2 v[164:165], v10, s[32:35], s26 offen offset:64 sc1
  buffer_load_dwordx2 v[166:167], v10, s[32:35], s26 offen offset:96 sc1
  .p2align 5
ffn2_loop:
  s_waitcnt lgkmcnt(0)
  v_mfma_f32_16x16x32_bf16 v[16:19], v[96:99], v[80:83], v[16:19]
  ds_read_b128 v[128:131], v7 offset:8192
  v_mfma_f32_16x16x32_bf16 v[32:35], v[96:99], v[84:87], v[32:35]
  ds_read_b128 v[112:115], v6 offset:1024
  v_mfma_f32_16x16x32_bf16 v[48:51], v[96:99], v[88:91], v[48:51]
  ds_read_b128 v[116:119], v6 offset:3072
  v_mfma_f32_16x16x32_bf16 v[64:67], v[96:99], v[92:95], v[64:67]
  ds_read_b128 v[120:123], v6 offset:5120
  v_mfma_f32_16x16x32_bf16 v[68:71], v[100:103], v[92:95], v[68:71]
  ds_read_b128 v[124:127], v6 offset:7168
  v_mfma_f32_16x16x32_bf16 v[52:55], v[100:103], v[88:91], v[52:55]
  ds_read_b128 v[132:135], v7 offset:9216
  v_mfma_f32_16x16x32_bf16 v[36:39], v[100:103], v[84:87], v[36:39]
  ds_read_b128 v[136:139], v7 offset:10240
  v_mfma_f32_16x16x32_bf16 v[20:23], v[100:103], v[80:83], v[20:23]
  ds_read_b128 v[140:143], v7 offset:11264
  v_mfma_f32_16x16x32_bf16 v[24:27], v[104:107], v[80:83], v[24:27]
  s_add_u32 s22, s22, 32768
  v_mfma_f32_16x16x32_bf16 v[40:43], v[104:107], v[84:87], v[40:43]
  s_cmp_eq_u32 s22, 131072
  v_mfma_f32_16x16x32_bf16 v[56:59], v[104:107], v[88:91], v[56:59]
  s_cselect_b32 s22, 0, s22
  v_mfma_f32_16x16x32_bf16 v[72:75], v[104:107], v[92:95], v[72:75]
  v_add_u32 v6, s22, v3
  v_mfma_f32_16x16x32_bf16 v[76:79], v[108:111], v[92:95], v[76:79]
  v_add_u32 v7, s22, v4
  v_mfma_f32_16x16x32_bf16 v[60:63], v[108:111], v[88:91], v[60:63]
  v_mfma_f32_16x16x32_bf16 v[44:47], v[108:111], v[84:87], v[44:47]
  v_mfma_f32_16x16x32_bf16 v[28:31], v[108:111], v[80:83], v[28:31]
  s_waitcnt lgkmcnt(0)
  s_barrier
  v_mfma_f32_16x16x32_bf16 v[16:19], v[128:131], v[112:115], v[16:19]
  ds_read_b128 v[96:99], v7 offset:0
  v_mfma_f32_16x16x32_bf16 v[32:35], v[128:131], v[116:119], v[32:35]
  ds_read_b128 v[80:83], v6 offset:0
  v_mfma_f32_16x16x32_bf16 v[48:51], v[128:131], v[120:123], v[48:51]
  ds_read_b128 v[84:87], v6 offset:2048
  v_mfma_f32_16x16x32_bf16 v[64:67], v[128:131], v[124:127], v[64:67]
  ds_read_b128 v[88:91], v6 offset:4096
  v_mfma_f32_16x16x32_bf16 v[68:71], v[132:135], v[124:127], v[68:71]
  ds_read_b128 v[92:95], v6 offset:6144
  v_mfma_f32_16x16x32_bf16 v[52:55], v[132:135], v[120:123], v[52:55]
  ds_read_b128 v[100:103], v7 offset:1024
  v_mfma_f32_16x16x32_bf16 v[36:39], v[132:135], v[116:119], v[36:39]
  ds_read_b128 v[104:107], v7 offset:2048
  v_mfma_f32_16x16x32_bf16 v[20:23], v[132:135], v[112:115], v[20:23]
  ds_read_b128 v[108:111], v7 offset:3072
  v_mfma_f32_16x16x32_bf16 v[24:27], v[136:139], v[112:115], v[24:27]
  v_mfma_f32_16x16x32_bf16 v[40:43], v[136:139], v[116:119], v[40:43]
  v_mfma_f32_16x16x32_bf16 v[56:59], v[136:139], v[120:123], v[56:59]
  v_mfma_f32_16x16x32_bf16 v[72:75], v[136:139], v[124:127], v[72:75]
  v_mfma_f32_16x16x32_bf16 v[76:79], v[140:143], v[124:127], v[76:79]
  v_mfma_f32_16x16x32_bf16 v[60:63], v[140:143], v[120:123], v[60:63]
  v_mfma_f32_16x16x32_bf16 v[44:47], v[140:143], v[116:119], v[44:47]
  v_mfma_f32_16x16x32_bf16 v[28:31], v[140:143], v[112:115], v[28:31]
  s_waitcnt lgkmcnt(0)
  v_mfma_f32_16x16x32_bf16 v[16:19], v[96:99], v[80:83], v[16:19]
  ds_read_b128 v[128:131], v7 offset:8192
  v_mfma_f32_16x16x32_bf16 v[32:35], v[96:99], v[84:87], v[32:35]
  ds_read_b128 v[112:115], v6 offset:1024
  v_mfma_f32_16x16x32_bf16 v[48:51], v[96:99], v[88:91], v[48:51]
  ds_read_b128 v[116:119], v6 offset:3072
  v_mfma_f32_16x16x32_bf16 v[64:67], v[96:99], v[92:95], v[64:67]
  ds_read_b128 v[120:123], v6 offset:5120
  v_mfma_f32_16x16x32_bf16 v[68:71], v[100:103], v[92:95], v[68:71]
  ds_read_b128 v[124:127], v6 offset:7168
  v_mfma_f32_16x16x32_bf16 v[52:55], v[100:103], v[88:91], v[52:55]
  ds_read_b128 v[132:135], v7 offset:9216
  v_mfma_f32_16x16x32_bf16 v[36:39], v[100:103], v[84:87], v[36:39]
  ds_read_b128 v[136:139], v7 offset:10240
  v_mfma_f32_16x16x32_bf16 v[20:23], v[100:103], v[80:83], v[20:23]
  ds_read_b128 v[140:143], v7 offset:11264
  v_mfma_f32_16x16x32_bf16 v[24:27], v[104:107], v[80:83], v[24:27]
  s_add_u32 s22, s22, 32768
  v_mfma_f32_16x16x32_bf16 v[40:43], v[104:107], v[84:87], v[40:43]
  s_cmp_eq_u32 s22, 131072
  v_mfma_f32_16x16x32_bf16 v[56:59], v[104:107], v[88:91], v[56:59]
  s_cselect_b32 s22, 0, s22
  v_mfma_f32_16x16x32_bf16 v[72:75], v[104:107], v[92:95], v[72:75]
  v_add_u32 v6, s22, v3
  v_mfma_f32_16x16x32_bf16 v[76:79], v[108:111], v[92:95], v[76:79]
  v_add_u32 v7, s22, v4
  v_mfma_f32_16x16x32_bf16 v[60:63], v[108:111], v[88:91], v[60:63]
  v_mfma_f32_16x16x32_bf16 v[44:47], v[108:111], v[84:87], v[44:47]
  v_mfma_f32_16x16x32_bf16 v[28:31], v[108:111], v[80:83], v[28:31]
  s_waitcnt lgkmcnt(0)
  s_barrier
  v_mfma_f32_16x16x32_bf16 v[16:19], v[128:131], v[112:115], v[16:19]
  ds_read_b128 v[96:99], v7 offset:0
  v_mfma_f32_16x16x32_bf16 v[32:35], v[128:131], v[116:119], v[32:35]
  ds_read_b128 v[80:83], v6 offset:0
  v_mfma_f32_16x16x32_bf16 v[48:51], v[128:131], v[120:123], v[48:51]
  ds_read_b128 v[84:87], v6 offset:2048
  v_mfma_f32_16x16x32_bf16 v[64:67], v[128:131], v[124:127], v[64:67]
  ds_read_b128 v[88:91], v6 offset:4096
  v_mfma_f32_16x16x32_bf16 v[68:71], v[132:135], v[124:127], v[68:71]
  ds_read_b128 v[92:95], v6 offset:6144
  v_mfma_f32_16x16x32_bf16 v[52:55], v[132:135], v[120:123], v[52:55]
  ds_read_b128 v[100:103], v7 offset:1024
  v_mfma_f32_16x16x32_bf16 v[36:39], v[132:135], v[116:119], v[36:39]
  ds_read_b128 v[104:107], v7 offset:2048
  v_mfma_f32_16x16x32_bf16 v[20:23], v[132:135], v[112:115], v[20:23]
  ds_read_b128 v[108:111], v7 offset:3072
  v_mfma_f32_16x16x32_bf16 v[24:27], v[136:139], v[112:115], v[24:27]
  s_sub_u32 s23, s23, 2
  v_mfma_f32_16x16x32_bf16 v[40:43], v[136:139], v[116:119], v[40:43]
  s_cmp_lg_u32 s23, 0
  v_mfma_f32_16x16x32_bf16 v[56:59], v[136:139], v[120:123], v[56:59]
  v_mfma_f32_16x16x32_bf16 v[72:75], v[136:139], v[124:127], v[72:75]
  v_mfma_f32_16x16x32_bf16 v[76:79], v[140:143], v[124:127], v[76:79]
  v_mfma_f32_16x16x32_bf16 v[60:63], v[140:143], v[120:123], v[60:63]
  v_mfma_f32_16x16x32_bf16 v[44:47], v[140:143], v[116:119], v[44:47]
  v_mfma_f32_16x16x32_bf16 v[28:31], v[140:143], v[112:115], v[28:31]
  s_cbranch_scc1 ffn2_loop
  s_add_u32 s36, s4, 0x2a00000
  s_addc_u32 s37, s5, 0
  s_mov_b32 s38, 0x40000
  s_mov_b32 s39, 0x20000
  s_lshl_b32 s24, s2, 2
  s_add_u32 s24, s24, s8
  s_lshl_b32 s56, s24, 12
  s_lshl_b32 s42, s24, 6
  s_add_u32 s42, s42, 163840
  s_lshl_b32 s24, s8, 13
  s_add_u32 s24, s24, 131072
  v_add_u32 v8, s24, v9
  s_waitcnt lgkmcnt(0)
  v_mfma_f32_16x16x32_bf16 v[16:19], v[96:99], v[80:83], v[16:19]
  ds_read_b128 v[128:131], v7 offset:8192
  v_mfma_f32_16x16x32_bf16 v[32:35], v[96:99], v[84:87], v[32:35]
  ds_read_b128 v[112:115], v6 offset:1024
  v_mfma_f32_16x16x32_bf16 v[36:39], v[100:103], v[84:87], v[36:39]
  ds_read_b128 v[116:119], v6 offset:3072
  v_mfma_f32_16x16x32_bf16 v[20:23], v[100:103], v[80:83], v[20:23]
  ds_read_b128 v[132:135], v7 offset:9216
  v_mfma_f32_16x16x32_bf16 v[24:27], v[104:107], v[80:83], v[24:27]
  ds_read_b128 v[136:139], v7 offset:10240
  v_mfma_f32_16x16x32_bf16 v[40:43], v[104:107], v[84:87], v[40:43]
  ds_read_b128 v[140:143], v7 offset:11264
  v_mfma_f32_16x16x32_bf16 v[44:47], v[108:111], v[84:87], v[44:47]
  v_add_u32 v6, 32768, v3
  v_mfma_f32_16x16x32_bf16 v[28:31], v[108:111], v[80:83], v[28:31]
  v_add_u32 v7, 32768, v4
  v_cvt_pk_bf16_f32 v48, v48, v49
  v_cvt_pk_bf16_f32 v49, v50, v51
  v_cvt_pk_bf16_f32 v50, v52, v53
  v_cvt_pk_bf16_f32 v51, v54, v55
  buffer_store_dwordx4 v[48:51], v9, s[52:55], s56 offen offset:0 sc1
  v_cvt_pk_bf16_f32 v56, v56, v57
  v_cvt_pk_bf16_f32 v57, v58, v59
  v_cvt_pk_bf16_f32 v58, v60, v61
  v_cvt_pk_bf16_f32 v59, v62, v63
  buffer_store_dwordx4 v[56:59], v9, s[52:55], s56 offen offset:1024 sc1
  s_waitcnt lgkmcnt(0)
  s_barrier
  v_mfma_f32_16x16x32_bf16 v[16:19], v[128:131], v[112:115], v[16:19]
  ds_read_b128 v[96:99], v7 offset:0
  v_mfma_f32_16x16x32_bf16 v[32:35], v[128:131], v[116:119], v[32:35]
  ds_read_b128 v[80:83], v6 offset:0
  v_mfma_f32_16x16x32_bf16 v[36:39], v[132:135], v[116:119], v[36:39]
  ds_read_b128 v[84:87], v6 offset:2048
  v_mfma_f32_16x16x32_bf16 v[20:23], v[132:135], v[112:115], v[20:23]
  ds_read_b128 v[100:103], v7 offset:1024
  v_mfma_f32_16x16x32_bf16 v[24:27], v[136:139], v[112:115], v[24:27]
  ds_read_b128 v[104:107], v7 offset:2048
  v_mfma_f32_16x16x32_bf16 v[40:43], v[136:139], v[116:119], v[40:43]
  ds_read_b128 v[108:111], v7 offset:3072
  v_mfma_f32_16x16x32_bf16 v[44:47], v[140:143], v[116:119], v[44:47]
  v_mfma_f32_16x16x32_bf16 v[28:31], v[140:143], v[112:115], v[28:31]
  v_cvt_pk_bf16_f32 v64, v64, v65
  v_cvt_pk_bf16_f32 v65, v66, v67
  v_cvt_pk_bf16_f32 v66, v68, v69
  v_cvt_pk_bf16_f32 v67, v70, v71
  buffer_store_dwordx4 v[64:67], v9, s[52:55], s56 offen offset:2048 sc1
  v_cvt_pk_bf16_f32 v72, v72, v73
  v_cvt_pk_bf16_f32 v73, v74, v75
  v_cvt_pk_bf16_f32 v74, v76, v77
  v_cvt_pk_bf16_f32 v75, v78, v79
  buffer_store_dwordx4 v[72:75], v9, s[52:55], s56 offen offset:3072 sc1
  s_waitcnt lgkmcnt(0)
  v_mfma_f32_16x16x32_bf16 v[16:19], v[96:99], v[80:83], v[16:19]
  ds_read_b128 v[128:131], v7 offset:8192
  v_mfma_f32_16x16x32_bf16 v[32:35], v[96:99], v[84:87], v[32:35]
  ds_read_b128 v[112:115], v6 offset:1024
  v_mfma_f32_16x16x32_bf16 v[36:39], v[100:103], v[84:87], v[36:39]
  ds_read_b128 v[116:119], v6 offset:3072
  v_mfma_f32_16x16x32_bf16 v[20:23], v[100:103], v[80:83], v[20:23]
  ds_read_b128 v[132:135], v7 offset:9216
  v_mfma_f32_16x16x32_bf16 v[24:27], v[104:107], v[80:83], v[24:27]
  ds_read_b128 v[136:139], v7 offset:10240
  v_mfma_f32_16x16x32_bf16 v[40:43], v[104:107], v[84:87], v[40:43]
  ds_read_b128 v[140:143], v7 offset:11264
  v_mfma_f32_16x16x32_bf16 v[44:47], v[108:111], v[84:87], v[44:47]
  v_add_u32 v6, 65536, v3
  v_mfma_f32_16x16x32_bf16 v[28:31], v[108:111], v[80:83], v[28:31]
  v_add_u32 v7, 65536, v4
  s_waitcnt lgkmcnt(0)
  s_barrier
  v_mfma_f32_16x16x32_bf16 v[16:19], v[128:131], v[112:115], v[16:19]
  ds_read_b128 v[96:99], v7 offset:0
  v_mfma_f32_16x16x32_bf16 v[32:35], v[128:131], v[116:119], v[32:35]
  ds_read_b128 v[80:83], v6 offset:0
  v_mfma_f32_16x16x32_bf16 v[36:39], v[132:135], v[116:119], v[36:39]
  ds_read_b128 v[84:87], v6 offset:2048
  v_mfma_f32_16x16x32_bf16 v[20:23], v[132:135], v[112:115], v[20:23]
  ds_read_b128 v[100:103], v7 offset:1024
  v_mfma_f32_16x16x32_bf16 v[24:27], v[136:139], v[112:115], v[24:27]
  ds_read_b128 v[104:107], v7 offset:2048
  v_mfma_f32_16x16x32_bf16 v[40:43], v[136:139], v[116:119], v[40:43]
  ds_read_b128 v[108:111], v7 offset:3072
  v_mfma_f32_16x16x32_bf16 v[44:47], v[140:143], v[116:119], v[44:47]
  v_mfma_f32_16x16x32_bf16 v[28:31], v[140:143], v[112:115], v[28:31]
  s_waitcnt lgkmcnt(0)
  v_mfma_f32_16x16x32_bf16 v[16:19], v[96:99], v[80:83], v[16:19]
  ds_read_b128 v[128:131], v7 offset:8192
  v_mfma_f32_16x16x32_bf16 v[32:35], v[96:99], v[84:87], v[32:35]
  ds_read_b128 v[112:115], v6 offset:1024
  v_mfma_f32_16x16x32_bf16 v[36:39], v[100:103], v[84:87], v[36:39]
  ds_read_b128 v[116:119], v6 offset:3072
  v_mfma_f32_16x16x32_bf16 v[20:23], v[100:103], v[80:83], v[20:23]
  ds_read_b128 v[132:135], v7 offset:9216
  v_mfma_f32_16x16x32_bf16 v[24:27], v[104:107], v[80:83], v[24:27]
  ds_read_b128 v[136:139], v7 offset:10240
  v_mfma_f32_16x16x32_bf16 v[40:43], v[104:107], v[84:87], v[40:43]
  ds_read_b128 v[140:143], v7 offset:11264
  v_mfma_f32_16x16x32_bf16 v[44:47], v[108:111], v[84:87], v[44:47]
  v_add_u32 v6, 98304, v3
  v_mfma_f32_16x16x32_bf16 v[28:31], v[108:111], v[80:83], v[28:31]
  v_add_u32 v7, 98304, v4
  s_waitcnt vmcnt(0)
  v_mov_b32 v12, 0
  v_mov_b32 v13, 1
  s_mov_b64 exec, 1
  buffer_store_dword v13, v12, s[36:39], s42 offen sc1
  s_mov_b64 exec, -1
  s_waitcnt lgkmcnt(0)
  s_barrier
  v_mfma_f32_16x16x32_bf16 v[16:19], v[128:131], v[112:115], v[16:19]
  ds_read_b128 v[96:99], v7 offset:0
  v_mfma_f32_16x16x32_bf16 v[32:35], v[128:131], v[116:119], v[32:35]
  ds_read_b128 v[80:83], v6 offset:0
  v_mfma_f32_16x16x32_bf16 v[36:39], v[132:135], v[116:119], v[36:39]
  ds_read_b128 v[84:87], v6 offset:2048
  v_mfma_f32_16x16x32_bf16 v[20:23], v[132:135], v[112:115], v[20:23]
  ds_read_b128 v[100:103], v7 offset:1024
  v_mfma_f32_16x16x32_bf16 v[24:27], v[136:139], v[112:115], v[24:27]
  ds_read_b128 v[104:107], v7 offset:2048
  v_mfma_f32_16x16x32_bf16 v[40:43], v[136:139], v[116:119], v[40:43]
  ds_read_b128 v[108:111], v7 offset:3072
  v_mfma_f32_16x16x32_bf16 v[44:47], v[140:143], v[116:119], v[44:47]
  v_mfma_f32_16x16x32_bf16 v[28:31], v[140:143], v[112:115], v[28:31]
  s_waitcnt lgkmcnt(0)
  v_mfma_f32_16x16x32_bf16 v[16:19], v[96:99], v[80:83], v[16:19]
  ds_read_b128 v[128:131], v7 offset:8192
  v_mfma_f32_16x16x32_bf16 v[32:35], v[96:99], v[84:87], v[32:35]
  ds_read_b128 v[112:115], v6 offset:1024
  v_mfma_f32_16x16x32_bf16 v[36:39], v[100:103], v[84:87], v[36:39]
  ds_read_b128 v[116:119], v6 offset:3072
  v_mfma_f32_16x16x32_bf16 v[20:23], v[100:103], v[80:83], v[20:23]
  ds_read_b128 v[132:135], v7 offset:9216
  v_mfma_f32_16x16x32_bf16 v[24:27], v[104:107], v[80:83], v[24:27]
  ds_read_b128 v[136:139], v7 offset:10240
  v_mfma_f32_16x16x32_bf16 v[40:43], v[104:107], v[84:87], v[40:43]
  ds_read_b128 v[140:143], v7 offset:11264
  v_mfma_f32_16x16x32_bf16 v[44:47], v[108:111], v[84:87], v[44:47]
  v_add_u32 v6, 0, v3
  v_mfma_f32_16x16x32_bf16 v[28:31], v[108:111], v[80:83], v[28:31]
  v_add_u32 v7, 0, v4
  v_lshlrev_b32 v48, 16, v144
  v_and_b32 v49, 0xffff0000, v144
  v_lshlrev_b32 v50, 16, v145
  v_and_b32 v51, 0xffff0000, v145
  v_lshlrev_b32 v52, 16, v146
  v_and_b32 v53, 0xffff0000, v146
  v_lshlrev_b32 v54, 16, v147
  v_and_b32 v55, 0xffff0000, v147
  v_lshlrev_b32 v56, 16, v148
  v_and_b32 v57, 0xffff0000, v148
  v_lshlrev_b32 v58, 16, v149
  v_and_b32 v59, 0xffff0000, v149
  v_lshlrev_b32 v60, 16, v150
  v_and_b32 v61, 0xffff0000, v150
  v_lshlrev_b32 v62, 16, v151
  v_and_b32 v63, 0xffff0000, v151
  s_waitcnt lgkmcnt(0)
  s_barrier
  v_mfma_f32_16x16x32_bf16 v[16:19], v[128:131], v[112:115], v[16:19]
  ds_read_b128 v[96:99], v7 offset:0
  v_mfma_f32_16x16x32_bf16 v[32:35], v[128:131], v[116:119], v[32:35]
  ds_read_b128 v[80:83], v6 offset:0
  v_mfma_f32_16x16x32_bf16 v[36:39], v[132:135], v[116:119], v[36:39]
  ds_read_b128 v[84:87], v6 offset:2048
  v_mfma_f32_16x16x32_bf16 v[20:23], v[132:135], v[112:115], v[20:23]
  ds_read_b128 v[100:103], v7 offset:1024
  v_mfma_f32_16x16x32_bf16 v[24:27], v[136:139], v[112:115], v[24:27]
  ds_read_b128 v[104:107], v7 offset:2048
  v_mfma_f32_16x16x32_bf16 v[40:43], v[136:139], v[116:119], v[40:43]
  ds_read_b128 v[108:111], v7 offset:3072
  v_mfma_f32_16x16x32_bf16 v[44:47], v[140:143], v[116:119], v[44:47]
  v_mfma_f32_16x16x32_bf16 v[28:31], v[140:143], v[112:115], v[28:31]
  s_waitcnt lgkmcnt(0)
  v_mfma_f32_16x16x32_bf16 v[16:19], v[96:99], v[80:83], v[16:19]
  ds_read_b128 v[128:131], v7 offset:8192
  v_mfma_f32_16x16x32_bf16 v[32:35], v[96:99], v[84:87], v[32:35]
  ds_read_b128 v[112:115], v6 offset:1024
  v_mfma_f32_16x16x32_bf16 v[36:39], v[100:103], v[84:87], v[36:39]
  ds_read_b128 v[116:119], v6 offset:3072
  v_mfma_f32_16x16x32_bf16 v[20:23], v[100:103], v[80:83], v[20:23]
  ds_read_b128 v[132:135], v7 offset:9216
  v_mfma_f32_16x16x32_bf16 v[24:27], v[104:107], v[80:83], v[24:27]
  ds_read_b128 v[136:139], v7 offset:10240
  v_mfma_f32_16x16x32_bf16 v[40:43], v[104:107], v[84:87], v[40:43]
  ds_read_b128 v[140:143], v7 offset:11264
  v_mfma_f32_16x16x32_bf16 v[44:47], v[108:111], v[84:87], v[44:47]
  v_add_u32 v6, 32768, v3
  v_mfma_f32_16x16x32_bf16 v[28:31], v[108:111], v[80:83], v[28:31]
  v_add_u32 v7, 32768, v4
  v_lshlrev_b32 v64, 16, v152
  v_and_b32 v65, 0xffff0000, v152
  v_lshlrev_b32 v66, 16, v153
  v_and_b32 v67, 0xffff0000, v153
  v_lshlrev_b32 v68, 16, v154
  v_and_b32 v69, 0xffff0000, v154
  v_lshlrev_b32 v70, 16, v155
  v_and_b32 v71, 0xffff0000, v155
  v_lshlrev_b32 v72, 16, v156
  v_and_b32 v73, 0xffff0000, v156
  v_lshlrev_b32 v74, 16, v157
  v_and_b32 v75, 0xffff0000, v157
  v_lshlrev_b32 v76, 16, v158
  v_and_b32 v77, 0xffff0000, v158
  v_lshlrev_b32 v78, 16, v159
  v_and_b32 v79, 0xffff0000, v159
  s_waitcnt lgkmcnt(0)
  s_barrier
  v_mfma_f32_16x16x32_bf16 v[16:19], v[128:131], v[112:115], v[16:19]
  ds_read_b128 v[96:99], v7 offset:0
  v_mfma_f32_16x16x32_bf16 v[32:35], v[128:131], v[116:119], v[32:35]
  ds_read_b128 v[80:83], v6 offset:0
  v_mfma_f32_16x16x32_bf16 v[36:39], v[132:135], v[116:119], v[36:39]
  ds_read_b128 v[84:87], v6 offset:2048
  v_mfma_f32_16x16x32_bf16 v[20:23], v[132:135], v[112:115], v[20:23]
  ds_read_b128 v[100:103], v7 offset:1024
  v_mfma_f32_16x16x32_bf16 v[24:27], v[136:139], v[112:115], v[24:27]
  ds_read_b128 v[104:107], v7 offset:2048
  v_mfma_f32_16x16x32_bf16 v[40:43], v[136:139], v[116:119], v[40:43]
  ds_read_b128 v[108:111], v7 offset:3072
  v_mfma_f32_16x16x32_bf16 v[44:47], v[140:143], v[116:119], v[44:47]
  v_mfma_f32_16x16x32_bf16 v[28:31], v[140:143], v[112:115], v[28:31]
  s_waitcnt lgkmcnt(0)
  v_mfma_f32_16x16x32_bf16 v[16:19], v[96:99], v[80:83], v[16:19]
  ds_read_b128 v[128:131], v7 offset:8192
  v_mfma_f32_16x16x32_bf16 v[32:35], v[96:99], v[84:87], v[32:35]
  ds_read_b128 v[112:115], v6 offset:1024
  v_mfma_f32_16x16x32_bf16 v[36:39], v[100:103], v[84:87], v[36:39]
  ds_read_b128 v[116:119], v6 offset:3072
  v_mfma_f32_16x16x32_bf16 v[20:23], v[100:103], v[80:83], v[20:23]
  ds_read_b128 v[132:135], v7 offset:9216
  v_mfma_f32_16x16x32_bf16 v[24:27], v[104:107], v[80:83], v[24:27]
  ds_read_b128 v[136:139], v7 offset:10240
  v_mfma_f32_16x16x32_bf16 v[40:43], v[104:107], v[84:87], v[40:43]
  ds_read_b128 v[140:143], v7 offset:11264
  v_mfma_f32_16x16x32_bf16 v[44:47], v[108:111], v[84:87], v[44:47]
  v_add_u32 v6, 65536, v3
  v_mfma_f32_16x16x32_bf16 v[28:31], v[108:111], v[80:83], v[28:31]
  v_add_u32 v7, 65536, v4
  v_lshlrev_b32 v14, 16, v160
  v_and_b32 v15, 0xffff0000, v160
  v_pk_add_f32 v[48:49], v[48:49], v[14:15]
  v_pk_add_f32 v[64:65], v[64:65], v[14:15]
  v_lshlrev_b32 v14, 16, v161
  v_and_b32 v15, 0xffff0000, v161
  v_pk_add_f32 v[50:51], v[50:51], v[14:15]
  v_pk_add_f32 v[66:67], v[66:67], v[14:15]
  v_lshlrev_b32 v14, 16, v162
  v_and_b32 v15, 0xffff0000, v162
  v_pk_add_f32 v[52:53], v[52:53], v[14:15]
  v_pk_add_f32 v[68:69], v[68:69], v[14:15]
  v_lshlrev_b32 v14, 16, v163
  v_and_b32 v15, 0xffff0000, v163
  v_pk_add_f32 v[54:55], v[54:55], v[14:15]
  v_pk_add_f32 v[70:71], v[70:71], v[14:15]
  s_waitcnt lgkmcnt(0)
  s_barrier
  v_mfma_f32_16x16x32_bf16 v[16:19], v[128:131], v[112:115], v[16:19]
  ds_read_b128 v[96:99], v7 offset:0
  v_mfma_f32_16x16x32_bf16 v[32:35], v[128:131], v[116:119], v[32:35]
  ds_read_b128 v[80:83], v6 offset:0
  v_mfma_f32_16x16x32_bf16 v[36:39], v[132:135], v[116:119], v[36:39]
  ds_read_b128 v[84:87], v6 offset:2048
  v_mfma_f32_16x16x32_bf16 v[20:23], v[132:135], v[112:115], v[20:23]
  ds_read_b128 v[100:103], v7 offset:1024
  v_mfma_f32_16x16x32_bf16 v[24:27], v[136:139], v[112:115], v[24:27]
  ds_read_b128 v[104:107], v7 offset:2048
  v_mfma_f32_16x16x32_bf16 v[40:43], v[136:139], v[116:119], v[40:43]
  ds_read_b128 v[108:111], v7 offset:3072
  v_mfma_f32_16x16x32_bf16 v[44:47], v[140:143], v[116:119], v[44:47]
  v_mfma_f32_16x16x32_bf16 v[28:31], v[140:143], v[112:115], v[28:31]
  s_waitcnt lgkmcnt(0)
  v_mfma_f32_16x16x32_bf16 v[16:19], v[96:99], v[80:83], v[16:19]
  ds_read_b128 v[128:131], v7 offset:8192
  v_mfma_f32_16x16x32_bf16 v[32:35], v[96:99], v[84:87], v[32:35]
  ds_read_b128 v[112:115], v6 offset:1024
  v_mfma_f32_16x16x32_bf16 v[36:39], v[100:103], v[84:87], v[36:39]
  ds_read_b128 v[116:119], v6 offset:3072
  v_mfma_f32_16x16x32_bf16 v[20:23], v[100:103], v[80:83], v[20:23]
  ds_read_b128 v[132:135], v7 offset:9216
  v_mfma_f32_16x16x32_bf16 v[24:27], v[104:107], v[80:83], v[24:27]
  ds_read_b128 v[136:139], v7 offset:10240
  v_mfma_f32_16x16x32_bf16 v[40:43], v[104:107], v[84:87], v[40:43]
  ds_read_b128 v[140:143], v7 offset:11264
  v_mfma_f32_16x16x32_bf16 v[44:47], v[108:111], v[84:87], v[44:47]
  v_add_u32 v6, 98304, v3
  v_mfma_f32_16x16x32_bf16 v[28:31], v[108:111], v[80:83], v[28:31]
  v_add_u32 v7, 98304, v4
  v_lshlrev_b32 v14, 16, v164
  v_and_b32 v15, 0xffff0000, v164
  v_pk_add_f32 v[56:57], v[56:57], v[14:15]
  v_pk_add_f32 v[72:73], v[72:73], v[14:15]
  v_lshlrev_b32 v14, 16, v165
  v_and_b32 v15, 0xffff0000, v165
  v_pk_add_f32 v[58:59], v[58:59], v[14:15]
  v_pk_add_f32 v[74:75], v[74:75], v[14:15]
  v_lshlrev_b32 v14, 16, v166
  v_and_b32 v15, 0xffff0000, v166
  v_pk_add_f32 v[60:61], v[60:61], v[14:15]
  v_pk_add_f32 v[76:77], v[76:77], v[14:15]
  v_lshlrev_b32 v14, 16, v167
  v_and_b32 v15, 0xffff0000, v167
  v_pk_add_f32 v[62:63], v[62:63], v[14:15]
  v_pk_add_f32 v[78:79], v[78:79], v[14:15]
  s_waitcnt lgkmcnt(0)
  s_barrier
  v_mfma_f32_16x16x32_bf16 v[16:19], v[128:131], v[112:115], v[16:19]
  ds_read_b128 v[96:99], v7 offset:0
  v_mfma_f32_16x16x32_bf16 v[32:35], v[128:131], v[116:119], v[32:35]
  ds_read_b128 v[80:83], v6 offset:0
  v_mfma_f32_16x16x32_bf16 v[36:39], v[132:135], v[116:119], v[36:39]
  ds_read_b128 v[84:87], v6 offset:2048
  v_mfma_f32_16x16x32_bf16 v[20:23], v[132:135], v[112:115], v[20:23]
  ds_read_b128 v[100:103], v7 offset:1024
  v_mfma_f32_16x16x32_bf16 v[24:27], v[136:139], v[112:115], v[24:27]
  ds_read_b128 v[104:107], v7 offset:2048
  v_mfma_f32_16x16x32_bf16 v[40:43], v[136:139], v[116:119], v[40:43]
  ds_read_b128 v[108:111], v7 offset:3072
  v_mfma_f32_16x16x32_bf16 v[44:47], v[140:143], v[116:119], v[44:47]
  v_mfma_f32_16x16x32_bf16 v[28:31], v[140:143], v[112:115], v[28:31]
  s_waitcnt lgkmcnt(0)
  v_mfma_f32_16x16x32_bf16 v[16:19], v[96:99], v[80:83], v[16:19]
  ds_read_b128 v[128:131], v7 offset:8192
  v_mfma_f32_16x16x32_bf16 v[32:35], v[96:99], v[84:87], v[32:35]
  ds_read_b128 v[112:115], v6 offset:1024
  v_mfma_f32_16x16x32_bf16 v[36:39], v[100:103], v[84:87], v[36:39]
  ds_read_b128 v[116:119], v6 offset:3072
  v_mfma_f32_16x16x32_bf16 v[20:23], v[100:103], v[80:83], v[20:23]
  ds_read_b128 v[132:135], v7 offset:9216
  v_mfma_f32_16x16x32_bf16 v[24:27], v[104:107], v[80:83], v[24:27]
  ds_read_b128 v[136:139], v7 offset:10240
  v_mfma_f32_16x16x32_bf16 v[40:43], v[104:107], v[84:87], v[40:43]
  ds_read_b128 v[140:143], v7 offset:11264
  v_mfma_f32_16x16x32_bf16 v[44:47], v[108:111], v[84:87], v[44:47]
  v_add_u32 v6, 0, v3
  v_mfma_f32_16x16x32_bf16 v[28:31], v[108:111], v[80:83], v[28:31]
  v_add_u32 v7, 0, v4
  s_waitcnt lgkmcnt(0)
  s_barrier
  v_mfma_f32_16x16x32_bf16 v[16:19], v[128:131], v[112:115], v[16:19]
  ds_read_b128 v[80:83], v8 offset:0
  v_mfma_f32_16x16x32_bf16 v[32:35], v[128:131], v[116:119], v[32:35]
  ds_read_b128 v[84:87], v8 offset:1024
  v_mfma_f32_16x16x32_bf16 v[36:39], v[132:135], v[116:119], v[36:39]
  ds_read_b128 v[88:91], v8 offset:2048
  v_mfma_f32_16x16x32_bf16 v[20:23], v[132:135], v[112:115], v[20:23]
  ds_read_b128 v[92:95], v8 offset:3072
  v_mfma_f32_16x16x32_bf16 v[24:27], v[136:139], v[112:115], v[24:27]
  v_mfma_f32_16x16x32_bf16 v[40:43], v[136:139], v[116:119], v[40:43]
  v_mfma_f32_16x16x32_bf16 v[44:47], v[140:143], v[116:119], v[44:47]
  v_mfma_f32_16x16x32_bf16 v[28:31], v[140:143], v[112:115], v[28:31]
  s_waitcnt lgkmcnt(0)
  s_nop 7
  v_lshlrev_b32 v12, 16, v80
  v_and_b32 v13, 0xffff0000, v80
  v_pk_add_f32 v[16:17], v[16:17], v[12:13]
  v_lshlrev_b32 v12, 16, v81
  v_and_b32 v13, 0xffff0000, v81
  v_pk_add_f32 v[18:19], v[18:19], v[12:13]
  v_lshlrev_b32 v12, 16, v82
  v_and_b32 v13, 0xffff0000, v82
  v_pk_add_f32 v[20:21], v[20:21], v[12:13]
  v_lshlrev_b32 v12, 16, v83
  v_and_b32 v13, 0xffff0000, v83
  v_pk_add_f32 v[22:23], v[22:23], v[12:13]
  v_lshlrev_b32 v12, 16, v84
  v_and_b32 v13, 0xffff0000, v84
  v_pk_add_f32 v[24:25], v[24:25], v[12:13]
  v_lshlrev_b32 v12, 16, v85
  v_and_b32 v13, 0xffff0000, v85
  v_pk_add_f32 v[26:27], v[26:27], v[12:13]
  v_lshlrev_b32 v12, 16, v86
  v_and_b32 v13, 0xffff0000, v86
  v_pk_add_f32 v[28:29], v[28:29], v[12:13]
  v_lshlrev_b32 v12, 16, v87
  v_and_b32 v13, 0xffff0000, v87
  v_pk_add_f32 v[30:31], v[30:31], v[12:13]
  v_lshlrev_b32 v12, 16, v88
  v_and_b32 v13, 0xffff0000, v88
  v_pk_add_f32 v[32:33], v[32:33], v[12:13]
  v_lshlrev_b32 v12, 16, v89
  v_and_b32 v13, 0xffff0000, v89
  v_pk_add_f32 v[34:35], v[34:35], v[12:13]
  v_lshlrev_b32 v12, 16, v90
  v_and_b32 v13, 0xffff0000, v90
  v_pk_add_f32 v[36:37], v[36:37], v[12:13]
  v_lshlrev_b32 v12, 16, v91
  v_and_b32 v13, 0xffff0000, v91
  v_pk_add_f32 v[38:39], v[38:39], v[12:13]
  v_lshlrev_b32 v12, 16, v92
  v_and_b32 v13, 0xffff0000, v92
  v_pk_add_f32 v[40:41], v[40:41], v[12:13]
  v_lshlrev_b32 v12, 16, v93
  v_and_b32 v13, 0xffff0000, v93
  v_pk_add_f32 v[42:43], v[42:43], v[12:13]
  v_lshlrev_b32 v12, 16, v94
  v_and_b32 v13, 0xffff0000, v94
  v_pk_add_f32 v[44:45], v[44:45], v[12:13]
  v_lshlrev_b32 v12, 16, v95
  v_and_b32 v13, 0xffff0000, v95
  v_pk_add_f32 v[46:47], v[46:47], v[12:13]
  v_pk_add_f32 v[16:17], v[16:17], v[48:49]
  v_pk_add_f32 v[18:19], v[18:19], v[50:51]
  v_pk_add_f32 v[20:21], v[20:21], v[52:53]
  v_pk_add_f32 v[22:23], v[22:23], v[54:55]
  v_pk_add_f32 v[24:25], v[24:25], v[56:57]
  v_pk_add_f32 v[26:27], v[26:27], v[58:59]
  v_pk_add_f32 v[28:29], v[28:29], v[60:61]
  v_pk_add_f32 v[30:31], v[30:31], v[62:63]
  v_pk_add_f32 v[32:33], v[32:33], v[64:65]
  v_pk_add_f32 v[34:35], v[34:35], v[66:67]
  v_pk_add_f32 v[36:37], v[36:37], v[68:69]
  v_pk_add_f32 v[38:39], v[38:39], v[70:71]
  v_pk_add_f32 v[40:41], v[40:41], v[72:73]
  v_pk_add_f32 v[42:43], v[42:43], v[74:75]
  v_pk_add_f32 v[44:45], v[44:45], v[76:77]
  v_pk_add_f32 v[46:47], v[46:47], v[78:79]
  s_lshl_b32 s24, s27, 15
  s_lshl_b32 s25, s10, 7
  s_add_u32 s24, s24, s25
  s_add_u32 s25, s24, 32768
  v_lshlrev_b32 v9, 11, v1
  v_and_b32 v10, 1, v2
  v_lshl_add_u32 v9, v10, 5, v9
  v_lshrrev_b32 v10, 1, v2
  v_lshl_add_u32 v9, v10, 4, v9
  v_cvt_pk_bf16_f32 v80, v16, v17
  v_cvt_pk_bf16_f32 v81, v18, v19
  v_cvt_pk_bf16_f32 v82, v20, v21
  v_cvt_pk_bf16_f32 v83, v22, v23
  v_cvt_pk_bf16_f32 v84, v24, v25
  v_cvt_pk_bf16_f32 v85, v26, v27
  v_cvt_pk_bf16_f32 v86, v28, v29
  v_cvt_pk_bf16_f32 v87, v30, v31
  v_cvt_pk_bf16_f32 v88, v32, v33
  v_cvt_pk_bf16_f32 v89, v34, v35
  v_cvt_pk_bf16_f32 v90, v36, v37
  v_cvt_pk_bf16_f32 v91, v38, v39
  v_cvt_pk_bf16_f32 v92, v40, v41
  v_cvt_pk_bf16_f32 v93, v42, v43
  v_cvt_pk_bf16_f32 v94, v44, v45
  v_cvt_pk_bf16_f32 v95, v46, v47
  s_nop 1
  v_permlane16_swap_b32 v80, v82
  v_permlane16_swap_b32 v81, v83
  buffer_store_dwordx4 v[80:83], v9, s[48:51], s24 offen offset:0 sc1
  v_permlane16_swap_b32 v84, v86
  v_permlane16_swap_b32 v85, v87
  buffer_store_dwordx4 v[84:87], v9, s[48:51], s24 offen offset:64 sc1
  v_permlane16_swap_b32 v88, v90
  v_permlane16_swap_b32 v89, v91
  buffer_store_dwordx4 v[88:91], v9, s[48:51], s25 offen offset:0 sc1
  v_permlane16_swap_b32 v92, v94
  v_permlane16_swap_b32 v93, v95
  buffer_store_dwordx4 v[92:95], v9, s[48:51], s25 offen offset:64 sc1
ffn2_done:
  s_mov_b64 exec, -1
  s_endpgm
main_end:
.section .rodata,"a"
.p2align 6
.amdhsa_kernel sequential_preLN__softmax_full_mha__dense_activation_gelu__prompt_kernel
  .amdhsa_next_free_vgpr 256
  .amdhsa_next_free_sgpr 102
  .amdhsa_accum_offset 256
  .amdhsa_group_segment_fixed_size 0
  .amdhsa_kernarg_size 88
  .amdhsa_user_sgpr_count 2
  .amdhsa_user_sgpr_kernarg_segment_ptr 1
  .amdhsa_system_sgpr_workgroup_id_x 1
.end_amdhsa_kernel
```
